```python
import torch

def _softmax(x, axis=-1):
    return torch.softmax(x, dim=axis)

def _gelu(x):
    return torch.nn.functional.gelu(x, approximate='tanh')

def _silu(x):
    return torch.nn.functional.silu(x)

def _sigmoid(x):
    return torch.sigmoid(x)

def _layernorm(x, axis=-1, eps=1e-05):
    m = x.mean(dim=axis, keepdim=True)
    v = x.var(dim=axis, keepdim=True, unbiased=False)
    return (x - m) / torch.sqrt(v + eps)

def _scatter_add(tgt, idx, src, axis=0):
    return tgt.clone().index_add_(axis, idx, src)

def _segment_sum(src, seg, n):
    out = torch.zeros((n,) + src.shape[1:], dtype=src.dtype)
    return out.index_add_(0, seg, src)

def _pad(x, pw):
    flat = tuple((v for pair in reversed(pw) for v in pair))
    return torch.nn.functional.pad(x, flat)
kernel_name = 'adaLN_cond__mha_block_cached__glu_gated_glu__decode'

def setup_inputs():

    _w = lambda a: (lambda t: t.to(torch.bfloat16) if t.is_floating_point() else t)(torch.as_tensor(a))

    def _A_setup():
        B, Sq, D = (1, 1, 576)
        H, Sk, Dh = (32, 8192, 128)
        return {'x': _w((lambda *s: torch.randn(*s, dtype=torch.bfloat16) * 0.05)(B, Sq, D)), 'k_cache': _w((lambda *s: torch.randn(*s, dtype=torch.bfloat16) * 3.2)(B, H, Sk, Dh)), 'v_cache': _w((lambda *s: torch.randn(*s, dtype=torch.bfloat16) * 0.4)(B, H, Sk, Dh)), 'wq': _w((lambda *s: torch.randn(*s, dtype=torch.bfloat16) * 3.2)(D, H * Dh) * D ** (-0.5)), 'wo': _w((lambda *s: torch.randn(*s, dtype=torch.bfloat16) * 0.4)(H * Dh, D) * (H * Dh) ** (-0.5))}
    _A_in = _A_setup()

    def _B_setup():
        B, S, D, F = (1, 1, 576, 4608)
        return {'x': _w((lambda *s: torch.randn(*s, dtype=torch.bfloat16) * 0.05)(B, S, D)), 'w_gate': _w((lambda *s: torch.randn(*s, dtype=torch.bfloat16) * 0.05)(D, F)), 'w_up': _w((lambda *s: torch.randn(*s, dtype=torch.bfloat16) * 0.05)(D, F)), 'w_down': _w((lambda *s: torch.randn(*s, dtype=torch.bfloat16) * 0.05)(F, D))}
    _B_in = _B_setup()
    return {'A_x': _A_in['x'], 'A_k_cache': _A_in['k_cache'], 'A_v_cache': _A_in['v_cache'], 'A_wq': _A_in['wq'], 'A_wo': _A_in['wo'], 'B_x': _B_in['x'], 'B_w_gate': _B_in['w_gate'], 'B_w_up': _B_in['w_up'], 'B_w_down': _B_in['w_down'], 'c': _w((lambda *s: torch.randn(*s, dtype=torch.bfloat16) * 0.2)(1, 576) * 8.0), 'w_mod': _w((lambda *s: torch.randn(*s, dtype=torch.bfloat16) * 0.2)(576, 6 * 576) * 576 ** (-0.5) * 8.0)}

def reference(A_x, A_k_cache, A_v_cache, A_wq, A_wo, B_x, B_w_gate, B_w_up, B_w_down, c, w_mod):

    def _A_ref(x, k_cache, v_cache, wq, wo):
        B, Sq, D = x.shape
        H, Dh = (32, 128)
        q = (lambda x, *d: x.permute(*d))((x @ wq).reshape(B, Sq, H, Dh), 0, 2, 1, 3)
        scores = torch.einsum('bhqd,bhkd->bhqk', q, k_cache) * Dh ** (-0.5)
        p = _softmax(scores, axis=-1)
        o = torch.einsum('bhqk,bhkd->bhqd', p, v_cache)
        return (lambda x, *d: x.permute(*d))(o, 0, 2, 1, 3).reshape(B, Sq, H * Dh) @ wo

    def _B_ref(x, w_gate, w_up, w_down):
        g = torch.einsum('bsd,df->bsf', x, w_gate)
        u = torch.einsum('bsd,df->bsf', x, w_up)
        h = _sigmoid(g) * u
        return torch.einsum('bsf,fd->bsd', h, w_down)
    x = A_x
    mod = (_silu(c) @ w_mod).reshape(c.shape[0], 6, 1, -1)
    sa, ca, ga, sb, cb, gb = (mod[:, 0].clone(), mod[:, 1].clone(), mod[:, 2].clone(), mod[:, 3].clone(), mod[:, 4].clone(), mod[:, 5].clone())
    h = _layernorm(x, axis=-1) * (1 + ca) + sa
    x = x + ga * _A_ref(h, A_k_cache, A_v_cache, A_wq, A_wo)
    h = _layernorm(x, axis=-1) * (1 + cb) + sb
    x = x + gb * _B_ref(h, B_w_gate, B_w_up, B_w_down)
    return x
```

```asm
; @launch grid=(256,1,1) block=(512,1,1) lds=131072
.amdgcn_target "amdgcn-amd-amdhsa--gfx950"
.text
.globl adaLN_cond__mha_block_cached__glu_gated_glu__decode_kernel
.p2align 8
.type adaLN_cond__mha_block_cached__glu_gated_glu__decode_kernel,@function
adaLN_cond__mha_block_cached__glu_gated_glu__decode_kernel:
    s_cmp_ge_u32 s2, 256
    s_cbranch_scc1 L_exit
    s_load_dwordx16 s[16:31], s[0:1], 0
    s_load_dwordx8 s[32:39], s[0:1], 64
    s_load_dwordx4 s[40:43], s[0:1], 96
    v_lshrrev_b32 v1, 6, v0
    v_and_b32 v3, 63, v0
    v_readfirstlane_b32 s3, v1
    v_and_b32 v8, 1, v3
    v_cmp_eq_u32 vcc, 1, v8
    v_mov_b32 v9, 0xffff
    v_mov_b32 v10, 0xffff0000
    v_cndmask_b32 v9, v9, v10, vcc
    v_bfe_u32 v8, v3, 1, 2
    v_cmp_eq_u32 vcc, 0, v8
    s_nop 1
    v_cndmask_b32 v4, 0, v9, vcc
    v_cmp_eq_u32 vcc, 1, v8
    s_nop 1
    v_cndmask_b32 v5, 0, v9, vcc
    v_cmp_eq_u32 vcc, 2, v8
    s_nop 1
    v_cndmask_b32 v6, 0, v9, vcc
    v_cmp_eq_u32 vcc, 3, v8
    s_nop 1
    v_cndmask_b32 v7, 0, v9, vcc
    s_mov_b32 s80, 0xffff0000
    s_mov_b32 s81, 0xff
    s_mov_b32 s100, s2
    s_lshl_b32 s65, s3, 10
    v_lshrrev_b32 v8, 4, v3
    v_lshlrev_b32 v8, 6, v8
    v_bfe_u32 v9, v3, 2, 2
    v_lshl_add_u32 v8, v9, 8, v8
    v_and_b32 v9, 3, v3
    v_lshl_add_u32 v8, v9, 4, v8
    v_add_u32 v1, s65, v8
    v_lshlrev_b32 v9, 4, v3
    v_add_u32 v2, s65, v9
    s_lshl_b32 s67, s100, 18
    s_cmp_ge_u32 s3, 4
    s_waitcnt lgkmcnt(0)
    s_cbranch_scc1 L_helper
    s_add_u32 s44, s18, s67
    s_addc_u32 s45, s19, 0
    s_mov_b32 s46, 262144
    s_mov_b32 s47, 0x20000
    s_mov_b32 s66, 0
    buffer_load_dwordx4 a[0:3], v1, s[44:47], s66 offen nt
    s_mov_b32 s66, 4096
    buffer_load_dwordx4 a[4:7], v1, s[44:47], s66 offen nt
    s_mov_b32 s66, 8192
    buffer_load_dwordx4 a[8:11], v1, s[44:47], s66 offen nt
    s_mov_b32 s66, 12288
    buffer_load_dwordx4 a[12:15], v1, s[44:47], s66 offen nt
    s_mov_b32 s66, 16384
    buffer_load_dwordx4 a[16:19], v1, s[44:47], s66 offen nt
    s_setprio 2
    s_add_u32 s48, s20, s67
    s_addc_u32 s49, s21, 0
    s_mov_b32 s50, 262144
    s_mov_b32 s51, 0x20000
    s_load_dword s64, s[42:43], 0
    s_mov_b32 s52, s42
    s_mov_b32 s53, s43
    s_mov_b32 s54, 3145728
    s_mov_b32 s55, 0x20000
    s_barrier
    v_lshrrev_b32 v8, 4, v3
    v_lshlrev_b32 v8, 7, v8
    v_and_b32 v9, 7, v3
    v_lshl_add_u32 v8, v9, 2, v8
    s_lshl_b32 s65, s3, 9
    s_add_u32 s65, s65, 6144
    v_add_u32 v64, s65, v8
    v_lshlrev_b32 v65, 4, v3
    s_mul_i32 s60, s3, 24576
    s_add_u32 s60, s60, 32768
    v_lshlrev_b32 v66, 4, v3
    v_add_u32 v66, s60, v66
    s_mov_b32 s6, 0x000f000f
    s_mov_b32 s7, 0x000f000f
    s_mov_b32 s8, 0x00f000f0
    s_mov_b32 s9, 0x00f000f0
    s_mov_b32 s10, 0x0f000f00
    s_mov_b32 s11, 0x0f000f00
    s_mov_b32 s12, 0xf000f000
    s_mov_b32 s13, 0xf000f000
    s_mov_b32 s14, 0x22222222
    s_mov_b32 s15, 0x22222222
    s_mov_b32 s4, 0x88888888
    s_mov_b32 s5, 0x88888888
    s_mov_b32 s62, 0xcccccccc
    s_mov_b32 s63, 0xcccccccc
    s_waitcnt vmcnt(4)
    s_mov_b32 s66, 20480
    buffer_load_dwordx4 a[20:23], v1, s[44:47], s66 offen nt
    s_waitcnt vmcnt(4)
    s_mov_b32 s66, 24576
    buffer_load_dwordx4 a[24:27], v1, s[44:47], s66 offen nt
    s_waitcnt vmcnt(4)
    s_mov_b32 s66, 28672
    buffer_load_dwordx4 a[28:31], v1, s[44:47], s66 offen nt
    s_waitcnt vmcnt(4)
    s_mov_b32 s66, 32768
    buffer_load_dwordx4 a[32:35], v1, s[44:47], s66 offen nt
    s_waitcnt vmcnt(4)
    s_mov_b32 s66, 36864
    buffer_load_dwordx4 a[36:39], v1, s[44:47], s66 offen nt
    s_waitcnt vmcnt(4)
    s_mov_b32 s66, 40960
    buffer_load_dwordx4 a[40:43], v1, s[44:47], s66 offen nt
    s_waitcnt vmcnt(4)
    s_mov_b32 s66, 45056
    buffer_load_dwordx4 a[44:47], v1, s[44:47], s66 offen nt
    s_waitcnt vmcnt(4)
    s_mov_b32 s66, 49152
    buffer_load_dwordx4 a[48:51], v1, s[44:47], s66 offen nt
    s_waitcnt vmcnt(4)
    s_mov_b32 s66, 53248
    buffer_load_dwordx4 a[52:55], v1, s[44:47], s66 offen nt
    s_waitcnt vmcnt(4)
    s_mov_b32 s66, 57344
    buffer_load_dwordx4 a[56:59], v1, s[44:47], s66 offen nt
    s_waitcnt vmcnt(4)
    s_mov_b32 s66, 61440
    buffer_load_dwordx4 a[60:63], v1, s[44:47], s66 offen nt
    s_waitcnt vmcnt(4)
    s_mov_b32 s66, 65536
    buffer_load_dwordx4 a[64:67], v1, s[44:47], s66 offen nt
    s_waitcnt vmcnt(4)
    s_mov_b32 s66, 69632
    buffer_load_dwordx4 a[68:71], v1, s[44:47], s66 offen nt
    s_waitcnt vmcnt(4)
    s_mov_b32 s66, 73728
    buffer_load_dwordx4 a[72:75], v1, s[44:47], s66 offen nt
    s_waitcnt vmcnt(4)
    s_mov_b32 s66, 77824
    buffer_load_dwordx4 a[76:79], v1, s[44:47], s66 offen nt
    s_waitcnt vmcnt(4)
    s_mov_b32 s66, 81920
    buffer_load_dwordx4 a[80:83], v1, s[44:47], s66 offen nt
    s_waitcnt vmcnt(4)
    s_mov_b32 s66, 86016
    buffer_load_dwordx4 a[84:87], v1, s[44:47], s66 offen nt
    s_waitcnt vmcnt(4)
    s_mov_b32 s66, 90112
    buffer_load_dwordx4 a[88:91], v1, s[44:47], s66 offen nt
    s_waitcnt vmcnt(4)
    s_mov_b32 s66, 94208
    buffer_load_dwordx4 a[92:95], v1, s[44:47], s66 offen nt
    s_waitcnt vmcnt(4)
    s_mov_b32 s66, 98304
    buffer_load_dwordx4 a[96:99], v1, s[44:47], s66 offen nt
    s_waitcnt vmcnt(4)
    s_mov_b32 s66, 102400
    buffer_load_dwordx4 a[100:103], v1, s[44:47], s66 offen nt
    s_waitcnt vmcnt(4)
    s_mov_b32 s66, 106496
    buffer_load_dwordx4 a[104:107], v1, s[44:47], s66 offen nt
    s_waitcnt vmcnt(4)
    s_mov_b32 s66, 110592
    buffer_load_dwordx4 a[108:111], v1, s[44:47], s66 offen nt
    s_waitcnt vmcnt(4)
    s_mov_b32 s66, 114688
    buffer_load_dwordx4 a[112:115], v1, s[44:47], s66 offen nt
    s_waitcnt vmcnt(4)
    s_mov_b32 s66, 118784
    buffer_load_dwordx4 a[116:119], v1, s[44:47], s66 offen nt
    s_waitcnt vmcnt(4)
    s_mov_b32 s66, 122880
    buffer_load_dwordx4 a[120:123], v1, s[44:47], s66 offen nt
    s_waitcnt vmcnt(4)
    s_mov_b32 s66, 126976
    buffer_load_dwordx4 a[124:127], v1, s[44:47], s66 offen nt
    s_waitcnt vmcnt(4)
    s_mov_b32 s66, 131072
    buffer_load_dwordx4 a[128:131], v1, s[44:47], s66 offen nt
    s_waitcnt vmcnt(4)
    s_mov_b32 s66, 135168
    buffer_load_dwordx4 a[132:135], v1, s[44:47], s66 offen nt
    s_waitcnt vmcnt(4)
    s_mov_b32 s66, 139264
    buffer_load_dwordx4 a[136:139], v1, s[44:47], s66 offen nt
    s_waitcnt vmcnt(4)
    s_mov_b32 s66, 143360
    buffer_load_dwordx4 a[140:143], v1, s[44:47], s66 offen nt
    s_waitcnt vmcnt(4)
    s_mov_b32 s66, 147456
    buffer_load_dwordx4 a[144:147], v1, s[44:47], s66 offen nt
    s_waitcnt vmcnt(4)
    s_mov_b32 s66, 151552
    buffer_load_dwordx4 a[148:151], v1, s[44:47], s66 offen nt
    s_waitcnt vmcnt(4)
    s_mov_b32 s66, 155648
    buffer_load_dwordx4 a[152:155], v1, s[44:47], s66 offen nt
    s_waitcnt vmcnt(4)
    s_mov_b32 s66, 159744
    buffer_load_dwordx4 a[156:159], v1, s[44:47], s66 offen nt
    s_waitcnt vmcnt(4)
    s_mov_b32 s66, 163840
    s_add_u32 m0, s60, 0
    s_nop 0
    buffer_load_dwordx4 v1, s[44:47], s66 offen nt lds
    s_waitcnt vmcnt(4)
    s_mov_b32 s66, 167936
    s_add_u32 m0, s60, 1024
    s_nop 0
    buffer_load_dwordx4 v1, s[44:47], s66 offen nt lds
    s_waitcnt vmcnt(4)
    s_mov_b32 s66, 172032
    s_add_u32 m0, s60, 2048
    s_nop 0
    buffer_load_dwordx4 v1, s[44:47], s66 offen nt lds
    s_waitcnt vmcnt(4)
    s_mov_b32 s66, 176128
    s_add_u32 m0, s60, 3072
    s_nop 0
    buffer_load_dwordx4 v1, s[44:47], s66 offen nt lds
    s_waitcnt vmcnt(4)
    s_mov_b32 s66, 180224
    s_add_u32 m0, s60, 4096
    s_nop 0
    buffer_load_dwordx4 v1, s[44:47], s66 offen nt lds
    s_waitcnt vmcnt(4)
    s_mov_b32 s66, 184320
    s_add_u32 m0, s60, 5120
    s_nop 0
    buffer_load_dwordx4 v1, s[44:47], s66 offen nt lds
    s_waitcnt vmcnt(4)
    s_mov_b32 s66, 188416
    s_add_u32 m0, s60, 6144
    s_nop 0
    buffer_load_dwordx4 v1, s[44:47], s66 offen nt lds
    s_waitcnt vmcnt(4)
    s_mov_b32 s66, 192512
    s_add_u32 m0, s60, 7168
    s_nop 0
    buffer_load_dwordx4 v1, s[44:47], s66 offen nt lds
    s_waitcnt vmcnt(4)
    s_mov_b32 s66, 196608
    s_add_u32 m0, s60, 8192
    s_nop 0
    buffer_load_dwordx4 v1, s[44:47], s66 offen nt lds
    s_waitcnt vmcnt(4)
    s_mov_b32 s66, 200704
    s_add_u32 m0, s60, 9216
    s_nop 0
    buffer_load_dwordx4 v1, s[44:47], s66 offen nt lds
    s_waitcnt vmcnt(4)
    s_mov_b32 s66, 204800
    s_add_u32 m0, s60, 10240
    s_nop 0
    buffer_load_dwordx4 v1, s[44:47], s66 offen nt lds
    s_waitcnt vmcnt(4)
    s_mov_b32 s66, 208896
    s_add_u32 m0, s60, 11264
    s_nop 0
    buffer_load_dwordx4 v1, s[44:47], s66 offen nt lds
    s_waitcnt vmcnt(4)
    s_mov_b32 s66, 212992
    s_add_u32 m0, s60, 12288
    s_nop 0
    buffer_load_dwordx4 v1, s[44:47], s66 offen nt lds
    s_waitcnt vmcnt(4)
    s_mov_b32 s66, 217088
    s_add_u32 m0, s60, 13312
    s_nop 0
    buffer_load_dwordx4 v1, s[44:47], s66 offen nt lds
    s_waitcnt vmcnt(4)
    s_mov_b32 s66, 221184
    s_add_u32 m0, s60, 14336
    s_nop 0
    buffer_load_dwordx4 v1, s[44:47], s66 offen nt lds
    s_waitcnt vmcnt(4)
    s_mov_b32 s66, 225280
    s_add_u32 m0, s60, 15360
    s_nop 0
    buffer_load_dwordx4 v1, s[44:47], s66 offen nt lds
    s_waitcnt vmcnt(4)
    s_mov_b32 s66, 229376
    s_add_u32 m0, s60, 16384
    s_nop 0
    buffer_load_dwordx4 v1, s[44:47], s66 offen nt lds
    s_waitcnt vmcnt(4)
    s_mov_b32 s66, 233472
    s_add_u32 m0, s60, 17408
    s_nop 0
    buffer_load_dwordx4 v1, s[44:47], s66 offen nt lds
    s_waitcnt vmcnt(4)
    s_mov_b32 s66, 237568
    s_add_u32 m0, s60, 18432
    s_nop 0
    buffer_load_dwordx4 v1, s[44:47], s66 offen nt lds
    s_waitcnt vmcnt(4)
    s_mov_b32 s66, 241664
    s_add_u32 m0, s60, 19456
    s_nop 0
    buffer_load_dwordx4 v1, s[44:47], s66 offen nt lds
    s_waitcnt vmcnt(4)
    s_mov_b32 s66, 245760
    s_add_u32 m0, s60, 20480
    s_nop 0
    buffer_load_dwordx4 v1, s[44:47], s66 offen nt lds
    s_waitcnt vmcnt(4)
    s_mov_b32 s66, 249856
    s_add_u32 m0, s60, 21504
    s_nop 0
    buffer_load_dwordx4 v1, s[44:47], s66 offen nt lds
    s_waitcnt vmcnt(4)
    s_mov_b32 s66, 253952
    s_add_u32 m0, s60, 22528
    s_nop 0
    buffer_load_dwordx4 v1, s[44:47], s66 offen nt lds
    s_waitcnt vmcnt(4)
    s_mov_b32 s66, 258048
    s_add_u32 m0, s60, 23552
    s_nop 0
    buffer_load_dwordx4 v1, s[44:47], s66 offen nt lds
    s_waitcnt lgkmcnt(0)
    s_add_u32 s64, s64, 1
    s_and_b32 s68, s64, 0xff
    v_mov_b32 v60, s68
    v_mov_b32 v62, 0
    s_mov_b32 s69, 0
Lspin_1:
    ds_read_b32 v61, v62
    s_waitcnt lgkmcnt(0)
    v_readfirstlane_b32 s68, v61
    s_nop 0
    s_cmp_ge_u32 s68, 1
    s_cbranch_scc1 Lspun_2
    s_sleep 1
    s_add_u32 s69, s69, 1
    s_cmp_lt_u32 s69, 800000
    s_cbranch_scc1 Lspin_1
Lspun_2:
    v_lshrrev_b32 v52, 4, v3
    v_lshlrev_b32 v52, 6, v52
    v_and_b32 v53, 3, v3
    v_lshl_add_u32 v52, v53, 4, v52
    ds_read_b128 v[56:59], v52 offset:64
    s_waitcnt lgkmcnt(0)
    v_cndmask_b32 v8, 0, v56, s[6:7]
    v_cndmask_b32 v9, 0, v57, s[6:7]
    v_cndmask_b32 v10, 0, v58, s[6:7]
    v_cndmask_b32 v11, 0, v59, s[6:7]
    v_cndmask_b32 v12, 0, v56, s[8:9]
    v_cndmask_b32 v13, 0, v57, s[8:9]
    v_cndmask_b32 v14, 0, v58, s[8:9]
    v_cndmask_b32 v15, 0, v59, s[8:9]
    v_cndmask_b32 v16, 0, v56, s[10:11]
    v_cndmask_b32 v17, 0, v57, s[10:11]
    v_cndmask_b32 v18, 0, v58, s[10:11]
    v_cndmask_b32 v19, 0, v59, s[10:11]
    v_cndmask_b32 v20, 0, v56, s[12:13]
    v_cndmask_b32 v21, 0, v57, s[12:13]
    v_cndmask_b32 v22, 0, v58, s[12:13]
    v_cndmask_b32 v23, 0, v59, s[12:13]
    s_waitcnt vmcnt(60)
    v_mfma_f32_16x16x32_bf16 v[40:43], a[0:3], v[8:11], 0
    v_mfma_f32_16x16x32_bf16 v[40:43], a[4:7], v[12:15], v[40:43]
    v_mfma_f32_16x16x32_bf16 v[40:43], a[8:11], v[16:19], v[40:43]
    v_mfma_f32_16x16x32_bf16 v[40:43], a[12:15], v[20:23], v[40:43]
    s_waitcnt vmcnt(4)
    s_mov_b32 s66, 0
    buffer_load_dwordx4 a[0:3], v2, s[48:51], s66 offen nt
    s_waitcnt vmcnt(4)
    s_mov_b32 s66, 4096
    buffer_load_dwordx4 a[4:7], v2, s[48:51], s66 offen nt
    s_waitcnt vmcnt(58)
    v_mfma_f32_16x16x32_bf16 v[44:47], a[16:19], v[8:11], 0
    v_mfma_f32_16x16x32_bf16 v[44:47], a[20:23], v[12:15], v[44:47]
    v_mfma_f32_16x16x32_bf16 v[44:47], a[24:27], v[16:19], v[44:47]
    v_mfma_f32_16x16x32_bf16 v[44:47], a[28:31], v[20:23], v[44:47]
    v_cndmask_b32 v52, v40, v41, s[14:15]
    v_cndmask_b32 v53, v42, v43, s[4:5]
    v_cndmask_b32 v52, v52, v53, s[62:63]
    s_nop 1
    v_add_f32_dpp v53, v52, v52 quad_perm:[1,0,3,2] row_mask:0xf bank_mask:0xf
    s_nop 1
    v_add_f32_dpp v24, v53, v53 quad_perm:[2,3,0,1] row_mask:0xf bank_mask:0xf
    s_waitcnt vmcnt(4)
    s_mov_b32 s66, 8192
    buffer_load_dwordx4 a[8:11], v2, s[48:51], s66 offen nt
    s_waitcnt vmcnt(4)
    s_mov_b32 s66, 12288
    buffer_load_dwordx4 a[12:15], v2, s[48:51], s66 offen nt
    s_waitcnt vmcnt(56)
    v_mfma_f32_16x16x32_bf16 v[40:43], a[32:35], v[8:11], 0
    v_mfma_f32_16x16x32_bf16 v[40:43], a[36:39], v[12:15], v[40:43]
    v_mfma_f32_16x16x32_bf16 v[40:43], a[40:43], v[16:19], v[40:43]
    v_mfma_f32_16x16x32_bf16 v[40:43], a[44:47], v[20:23], v[40:43]
    v_cndmask_b32 v52, v44, v45, s[14:15]
    v_cndmask_b32 v53, v46, v47, s[4:5]
    v_cndmask_b32 v52, v52, v53, s[62:63]
    s_nop 1
    v_add_f32_dpp v53, v52, v52 quad_perm:[1,0,3,2] row_mask:0xf bank_mask:0xf
    s_nop 1
    v_add_f32_dpp v25, v53, v53 quad_perm:[2,3,0,1] row_mask:0xf bank_mask:0xf
    s_waitcnt vmcnt(4)
    s_mov_b32 s66, 16384
    buffer_load_dwordx4 a[16:19], v2, s[48:51], s66 offen nt
    s_waitcnt vmcnt(4)
    s_mov_b32 s66, 20480
    buffer_load_dwordx4 a[20:23], v2, s[48:51], s66 offen nt
    s_waitcnt vmcnt(54)
    v_mfma_f32_16x16x32_bf16 v[44:47], a[48:51], v[8:11], 0
    v_mfma_f32_16x16x32_bf16 v[44:47], a[52:55], v[12:15], v[44:47]
    v_mfma_f32_16x16x32_bf16 v[44:47], a[56:59], v[16:19], v[44:47]
    v_mfma_f32_16x16x32_bf16 v[44:47], a[60:63], v[20:23], v[44:47]
    v_cndmask_b32 v52, v40, v41, s[14:15]
    v_cndmask_b32 v53, v42, v43, s[4:5]
    v_cndmask_b32 v52, v52, v53, s[62:63]
    s_nop 1
    v_add_f32_dpp v53, v52, v52 quad_perm:[1,0,3,2] row_mask:0xf bank_mask:0xf
    s_nop 1
    v_add_f32_dpp v26, v53, v53 quad_perm:[2,3,0,1] row_mask:0xf bank_mask:0xf
    s_waitcnt vmcnt(4)
    s_mov_b32 s66, 24576
    buffer_load_dwordx4 a[24:27], v2, s[48:51], s66 offen nt
    s_waitcnt vmcnt(51)
    v_mfma_f32_16x16x32_bf16 v[40:43], a[64:67], v[8:11], 0
    v_mfma_f32_16x16x32_bf16 v[40:43], a[68:71], v[12:15], v[40:43]
    v_mfma_f32_16x16x32_bf16 v[40:43], a[72:75], v[16:19], v[40:43]
    v_mfma_f32_16x16x32_bf16 v[40:43], a[76:79], v[20:23], v[40:43]
    v_cndmask_b32 v52, v44, v45, s[14:15]
    v_cndmask_b32 v53, v46, v47, s[4:5]
    v_cndmask_b32 v52, v52, v53, s[62:63]
    s_nop 1
    v_add_f32_dpp v53, v52, v52 quad_perm:[1,0,3,2] row_mask:0xf bank_mask:0xf
    s_nop 1
    v_add_f32_dpp v27, v53, v53 quad_perm:[2,3,0,1] row_mask:0xf bank_mask:0xf
    s_waitcnt vmcnt(4)
    s_mov_b32 s66, 28672
    buffer_load_dwordx4 a[28:31], v2, s[48:51], s66 offen nt
    s_waitcnt vmcnt(48)
    v_mfma_f32_16x16x32_bf16 v[44:47], a[80:83], v[8:11], 0
    v_mfma_f32_16x16x32_bf16 v[44:47], a[84:87], v[12:15], v[44:47]
    v_mfma_f32_16x16x32_bf16 v[44:47], a[88:91], v[16:19], v[44:47]
    v_mfma_f32_16x16x32_bf16 v[44:47], a[92:95], v[20:23], v[44:47]
    v_cndmask_b32 v52, v40, v41, s[14:15]
    v_cndmask_b32 v53, v42, v43, s[4:5]
    v_cndmask_b32 v52, v52, v53, s[62:63]
    s_nop 1
    v_add_f32_dpp v53, v52, v52 quad_perm:[1,0,3,2] row_mask:0xf bank_mask:0xf
    s_nop 1
    v_add_f32_dpp v28, v53, v53 quad_perm:[2,3,0,1] row_mask:0xf bank_mask:0xf
    s_waitcnt vmcnt(4)
    s_mov_b32 s66, 32768
    buffer_load_dwordx4 a[32:35], v2, s[48:51], s66 offen nt
    s_waitcnt vmcnt(45)
    v_mfma_f32_16x16x32_bf16 v[40:43], a[96:99], v[8:11], 0
    v_mfma_f32_16x16x32_bf16 v[40:43], a[100:103], v[12:15], v[40:43]
    v_mfma_f32_16x16x32_bf16 v[40:43], a[104:107], v[16:19], v[40:43]
    v_mfma_f32_16x16x32_bf16 v[40:43], a[108:111], v[20:23], v[40:43]
    v_cndmask_b32 v52, v44, v45, s[14:15]
    v_cndmask_b32 v53, v46, v47, s[4:5]
    v_cndmask_b32 v52, v52, v53, s[62:63]
    s_nop 1
    v_add_f32_dpp v53, v52, v52 quad_perm:[1,0,3,2] row_mask:0xf bank_mask:0xf
    s_nop 1
    v_add_f32_dpp v29, v53, v53 quad_perm:[2,3,0,1] row_mask:0xf bank_mask:0xf
    s_waitcnt vmcnt(4)
    s_mov_b32 s66, 36864
    buffer_load_dwordx4 a[36:39], v2, s[48:51], s66 offen nt
    s_waitcnt vmcnt(42)
    v_mfma_f32_16x16x32_bf16 v[44:47], a[112:115], v[8:11], 0
    v_mfma_f32_16x16x32_bf16 v[44:47], a[116:119], v[12:15], v[44:47]
    v_mfma_f32_16x16x32_bf16 v[44:47], a[120:123], v[16:19], v[44:47]
    v_mfma_f32_16x16x32_bf16 v[44:47], a[124:127], v[20:23], v[44:47]
    v_cndmask_b32 v52, v40, v41, s[14:15]
    v_cndmask_b32 v53, v42, v43, s[4:5]
    v_cndmask_b32 v52, v52, v53, s[62:63]
    s_nop 1
    v_add_f32_dpp v53, v52, v52 quad_perm:[1,0,3,2] row_mask:0xf bank_mask:0xf
    s_nop 1
    v_add_f32_dpp v30, v53, v53 quad_perm:[2,3,0,1] row_mask:0xf bank_mask:0xf
    s_waitcnt vmcnt(4)
    s_mov_b32 s66, 40960
    buffer_load_dwordx4 a[40:43], v2, s[48:51], s66 offen nt
    s_waitcnt vmcnt(39)
    v_mfma_f32_16x16x32_bf16 v[40:43], a[128:131], v[8:11], 0
    v_mfma_f32_16x16x32_bf16 v[40:43], a[132:135], v[12:15], v[40:43]
    v_mfma_f32_16x16x32_bf16 v[40:43], a[136:139], v[16:19], v[40:43]
    v_mfma_f32_16x16x32_bf16 v[40:43], a[140:143], v[20:23], v[40:43]
    v_cndmask_b32 v52, v44, v45, s[14:15]
    v_cndmask_b32 v53, v46, v47, s[4:5]
    v_cndmask_b32 v52, v52, v53, s[62:63]
    s_nop 1
    v_add_f32_dpp v53, v52, v52 quad_perm:[1,0,3,2] row_mask:0xf bank_mask:0xf
    s_nop 1
    v_add_f32_dpp v31, v53, v53 quad_perm:[2,3,0,1] row_mask:0xf bank_mask:0xf
    s_waitcnt vmcnt(4)
    s_mov_b32 s66, 45056
    buffer_load_dwordx4 a[44:47], v2, s[48:51], s66 offen nt
    s_waitcnt vmcnt(36)
    v_mfma_f32_16x16x32_bf16 v[44:47], a[144:147], v[8:11], 0
    v_mfma_f32_16x16x32_bf16 v[44:47], a[148:151], v[12:15], v[44:47]
    v_mfma_f32_16x16x32_bf16 v[44:47], a[152:155], v[16:19], v[44:47]
    v_mfma_f32_16x16x32_bf16 v[44:47], a[156:159], v[20:23], v[44:47]
    v_cndmask_b32 v52, v40, v41, s[14:15]
    v_cndmask_b32 v53, v42, v43, s[4:5]
    v_cndmask_b32 v52, v52, v53, s[62:63]
    s_nop 1
    v_add_f32_dpp v53, v52, v52 quad_perm:[1,0,3,2] row_mask:0xf bank_mask:0xf
    s_nop 1
    v_add_f32_dpp v32, v53, v53 quad_perm:[2,3,0,1] row_mask:0xf bank_mask:0xf
    s_waitcnt vmcnt(4)
    s_mov_b32 s66, 49152
    buffer_load_dwordx4 a[48:51], v2, s[48:51], s66 offen nt
    s_waitcnt vmcnt(33)
    ds_read_b128 v[68:71], v66 offset:0
    ds_read_b128 v[72:75], v66 offset:1024
    ds_read_b128 v[76:79], v66 offset:2048
    ds_read_b128 v[80:83], v66 offset:3072
    s_waitcnt lgkmcnt(0)
    v_mfma_f32_16x16x32_bf16 v[40:43], v[68:71], v[8:11], 0
    v_mfma_f32_16x16x32_bf16 v[40:43], v[72:75], v[12:15], v[40:43]
    v_mfma_f32_16x16x32_bf16 v[40:43], v[76:79], v[16:19], v[40:43]
    v_mfma_f32_16x16x32_bf16 v[40:43], v[80:83], v[20:23], v[40:43]
    v_cndmask_b32 v52, v44, v45, s[14:15]
    v_cndmask_b32 v53, v46, v47, s[4:5]
    v_cndmask_b32 v52, v52, v53, s[62:63]
    s_nop 1
    v_add_f32_dpp v53, v52, v52 quad_perm:[1,0,3,2] row_mask:0xf bank_mask:0xf
    s_nop 1
    v_add_f32_dpp v33, v53, v53 quad_perm:[2,3,0,1] row_mask:0xf bank_mask:0xf
    s_waitcnt vmcnt(4)
    s_mov_b32 s66, 53248
    buffer_load_dwordx4 a[52:55], v2, s[48:51], s66 offen nt
    s_waitcnt vmcnt(30)
    ds_read_b128 v[68:71], v66 offset:4096
    ds_read_b128 v[72:75], v66 offset:5120
    ds_read_b128 v[76:79], v66 offset:6144
    ds_read_b128 v[80:83], v66 offset:7168
    s_waitcnt lgkmcnt(0)
    v_mfma_f32_16x16x32_bf16 v[44:47], v[68:71], v[8:11], 0
    v_mfma_f32_16x16x32_bf16 v[44:47], v[72:75], v[12:15], v[44:47]
    v_mfma_f32_16x16x32_bf16 v[44:47], v[76:79], v[16:19], v[44:47]
    v_mfma_f32_16x16x32_bf16 v[44:47], v[80:83], v[20:23], v[44:47]
    v_cndmask_b32 v52, v40, v41, s[14:15]
    v_cndmask_b32 v53, v42, v43, s[4:5]
    v_cndmask_b32 v52, v52, v53, s[62:63]
    s_nop 1
    v_add_f32_dpp v53, v52, v52 quad_perm:[1,0,3,2] row_mask:0xf bank_mask:0xf
    s_nop 1
    v_add_f32_dpp v34, v53, v53 quad_perm:[2,3,0,1] row_mask:0xf bank_mask:0xf
    s_waitcnt vmcnt(4)
    s_mov_b32 s66, 57344
    buffer_load_dwordx4 a[56:59], v2, s[48:51], s66 offen nt
    s_waitcnt vmcnt(27)
    ds_read_b128 v[68:71], v66 offset:8192
    ds_read_b128 v[72:75], v66 offset:9216
    ds_read_b128 v[76:79], v66 offset:10240
    ds_read_b128 v[80:83], v66 offset:11264
    s_waitcnt lgkmcnt(0)
    v_mfma_f32_16x16x32_bf16 v[40:43], v[68:71], v[8:11], 0
    v_mfma_f32_16x16x32_bf16 v[40:43], v[72:75], v[12:15], v[40:43]
    v_mfma_f32_16x16x32_bf16 v[40:43], v[76:79], v[16:19], v[40:43]
    v_mfma_f32_16x16x32_bf16 v[40:43], v[80:83], v[20:23], v[40:43]
    v_cndmask_b32 v52, v44, v45, s[14:15]
    v_cndmask_b32 v53, v46, v47, s[4:5]
    v_cndmask_b32 v52, v52, v53, s[62:63]
    s_nop 1
    v_add_f32_dpp v53, v52, v52 quad_perm:[1,0,3,2] row_mask:0xf bank_mask:0xf
    s_nop 1
    v_add_f32_dpp v35, v53, v53 quad_perm:[2,3,0,1] row_mask:0xf bank_mask:0xf
    s_waitcnt vmcnt(4)
    s_mov_b32 s66, 61440
    buffer_load_dwordx4 a[60:63], v2, s[48:51], s66 offen nt
    s_waitcnt vmcnt(24)
    ds_read_b128 v[68:71], v66 offset:12288
    ds_read_b128 v[72:75], v66 offset:13312
    ds_read_b128 v[76:79], v66 offset:14336
    ds_read_b128 v[80:83], v66 offset:15360
    s_waitcnt lgkmcnt(0)
    v_mfma_f32_16x16x32_bf16 v[44:47], v[68:71], v[8:11], 0
    v_mfma_f32_16x16x32_bf16 v[44:47], v[72:75], v[12:15], v[44:47]
    v_mfma_f32_16x16x32_bf16 v[44:47], v[76:79], v[16:19], v[44:47]
    v_mfma_f32_16x16x32_bf16 v[44:47], v[80:83], v[20:23], v[44:47]
    v_cndmask_b32 v52, v40, v41, s[14:15]
    v_cndmask_b32 v53, v42, v43, s[4:5]
    v_cndmask_b32 v52, v52, v53, s[62:63]
    s_nop 1
    v_add_f32_dpp v53, v52, v52 quad_perm:[1,0,3,2] row_mask:0xf bank_mask:0xf
    s_nop 1
    v_add_f32_dpp v36, v53, v53 quad_perm:[2,3,0,1] row_mask:0xf bank_mask:0xf
    s_waitcnt vmcnt(4)
    s_mov_b32 s66, 65536
    buffer_load_dwordx4 a[64:67], v2, s[48:51], s66 offen nt
    s_waitcnt vmcnt(21)
    ds_read_b128 v[68:71], v66 offset:16384
    ds_read_b128 v[72:75], v66 offset:17408
    ds_read_b128 v[76:79], v66 offset:18432
    ds_read_b128 v[80:83], v66 offset:19456
    s_waitcnt lgkmcnt(0)
    v_mfma_f32_16x16x32_bf16 v[40:43], v[68:71], v[8:11], 0
    v_mfma_f32_16x16x32_bf16 v[40:43], v[72:75], v[12:15], v[40:43]
    v_mfma_f32_16x16x32_bf16 v[40:43], v[76:79], v[16:19], v[40:43]
    v_mfma_f32_16x16x32_bf16 v[40:43], v[80:83], v[20:23], v[40:43]
    v_cndmask_b32 v52, v44, v45, s[14:15]
    v_cndmask_b32 v53, v46, v47, s[4:5]
    v_cndmask_b32 v52, v52, v53, s[62:63]
    s_nop 1
    v_add_f32_dpp v53, v52, v52 quad_perm:[1,0,3,2] row_mask:0xf bank_mask:0xf
    s_nop 1
    v_add_f32_dpp v37, v53, v53 quad_perm:[2,3,0,1] row_mask:0xf bank_mask:0xf
    s_waitcnt vmcnt(4)
    s_mov_b32 s66, 69632
    buffer_load_dwordx4 a[68:71], v2, s[48:51], s66 offen nt
    s_waitcnt vmcnt(18)
    ds_read_b128 v[68:71], v66 offset:20480
    ds_read_b128 v[72:75], v66 offset:21504
    ds_read_b128 v[76:79], v66 offset:22528
    ds_read_b128 v[80:83], v66 offset:23552
    s_waitcnt lgkmcnt(0)
    v_mfma_f32_16x16x32_bf16 v[44:47], v[68:71], v[8:11], 0
    v_mfma_f32_16x16x32_bf16 v[44:47], v[72:75], v[12:15], v[44:47]
    v_mfma_f32_16x16x32_bf16 v[44:47], v[76:79], v[16:19], v[44:47]
    v_mfma_f32_16x16x32_bf16 v[44:47], v[80:83], v[20:23], v[44:47]
    v_cndmask_b32 v52, v40, v41, s[14:15]
    v_cndmask_b32 v53, v42, v43, s[4:5]
    v_cndmask_b32 v52, v52, v53, s[62:63]
    s_nop 1
    v_add_f32_dpp v53, v52, v52 quad_perm:[1,0,3,2] row_mask:0xf bank_mask:0xf
    s_nop 1
    v_add_f32_dpp v38, v53, v53 quad_perm:[2,3,0,1] row_mask:0xf bank_mask:0xf
    s_waitcnt vmcnt(4)
    s_mov_b32 s66, 73728
    buffer_load_dwordx4 a[72:75], v2, s[48:51], s66 offen nt
    v_cndmask_b32 v52, v44, v45, s[14:15]
    v_cndmask_b32 v53, v46, v47, s[4:5]
    v_cndmask_b32 v52, v52, v53, s[62:63]
    s_nop 1
    v_add_f32_dpp v53, v52, v52 quad_perm:[1,0,3,2] row_mask:0xf bank_mask:0xf
    s_nop 1
    v_add_f32_dpp v39, v53, v53 quad_perm:[2,3,0,1] row_mask:0xf bank_mask:0xf
    s_mov_b32 s66, 77824
    buffer_load_dwordx4 a[76:79], v2, s[48:51], s66 offen nt
    s_mov_b32 s66, 81920
    buffer_load_dwordx4 a[80:83], v2, s[48:51], s66 offen nt
    s_mov_b32 s66, 86016
    buffer_load_dwordx4 a[84:87], v2, s[48:51], s66 offen nt
    s_mov_b32 s65, 0x3db504f3
    v_cvt_pk_bf16_f32 v52, v24, v25
    v_lshlrev_b32 v24, 16, v52
    v_and_b32 v25, s80, v52
    v_mul_f32 v24, s65, v24
    v_mul_f32 v25, s65, v25
    v_cvt_pk_bf16_f32 v52, v24, v25
    v_lshlrev_b32 v24, 16, v52
    v_and_b32 v25, s80, v52
    v_cvt_pk_bf16_f32 v53, v26, v27
    v_lshlrev_b32 v26, 16, v53
    v_and_b32 v27, s80, v53
    v_mul_f32 v26, s65, v26
    v_mul_f32 v27, s65, v27
    v_cvt_pk_bf16_f32 v53, v26, v27
    v_lshlrev_b32 v26, 16, v53
    v_and_b32 v27, s80, v53
    v_cvt_pk_bf16_f32 v54, v28, v29
    v_lshlrev_b32 v28, 16, v54
    v_and_b32 v29, s80, v54
    v_mul_f32 v28, s65, v28
    v_mul_f32 v29, s65, v29
    v_cvt_pk_bf16_f32 v54, v28, v29
    v_lshlrev_b32 v28, 16, v54
    v_and_b32 v29, s80, v54
    v_cvt_pk_bf16_f32 v55, v30, v31
    v_lshlrev_b32 v30, 16, v55
    v_and_b32 v31, s80, v55
    v_mul_f32 v30, s65, v30
    v_mul_f32 v31, s65, v31
    v_cvt_pk_bf16_f32 v55, v30, v31
    v_lshlrev_b32 v30, 16, v55
    v_and_b32 v31, s80, v55
    v_cvt_pk_bf16_f32 v52, v32, v33
    v_lshlrev_b32 v32, 16, v52
    v_and_b32 v33, s80, v52
    v_mul_f32 v32, s65, v32
    v_mul_f32 v33, s65, v33
    v_cvt_pk_bf16_f32 v52, v32, v33
    v_lshlrev_b32 v32, 16, v52
    v_and_b32 v33, s80, v52
    v_cvt_pk_bf16_f32 v53, v34, v35
    v_lshlrev_b32 v34, 16, v53
    v_and_b32 v35, s80, v53
    v_mul_f32 v34, s65, v34
    v_mul_f32 v35, s65, v35
    v_cvt_pk_bf16_f32 v53, v34, v35
    v_lshlrev_b32 v34, 16, v53
    v_and_b32 v35, s80, v53
    v_cvt_pk_bf16_f32 v54, v36, v37
    v_lshlrev_b32 v36, 16, v54
    v_and_b32 v37, s80, v54
    v_mul_f32 v36, s65, v36
    v_mul_f32 v37, s65, v37
    v_cvt_pk_bf16_f32 v54, v36, v37
    v_lshlrev_b32 v36, 16, v54
    v_and_b32 v37, s80, v54
    v_cvt_pk_bf16_f32 v55, v38, v39
    v_lshlrev_b32 v38, 16, v55
    v_and_b32 v39, s80, v55
    v_mul_f32 v38, s65, v38
    v_mul_f32 v39, s65, v39
    v_cvt_pk_bf16_f32 v55, v38, v39
    v_lshlrev_b32 v38, 16, v55
    v_and_b32 v39, s80, v55
    v_max3_f32 v56, v24, v25, v26
    v_max3_f32 v56, v56, v27, v28
    v_max3_f32 v56, v56, v29, v30
    v_max3_f32 v56, v56, v31, v32
    v_max3_f32 v56, v56, v33, v34
    v_max3_f32 v56, v56, v35, v36
    v_max3_f32 v56, v56, v37, v38
    v_max_f32 v56, v56, v39
    s_nop 1
    v_max_f32_dpp v56, v56, v56 row_ror:4 row_mask:0xf bank_mask:0xf
    s_nop 1
    v_max_f32_dpp v56, v56, v56 row_ror:8 row_mask:0xf bank_mask:0xf
    v_mov_b32 v52, v56
    s_nop 1
    v_permlane16_swap_b32 v56, v52
    v_max_f32 v56, v56, v52
    v_mov_b32 v52, v56
    s_nop 1
    v_permlane32_swap_b32 v56, v52
    v_max_f32 v56, v56, v52
    s_mov_b32 s65, 0x3fb8aa3b
    v_mul_f32 v55, s65, v56
    v_fma_f32 v24, v24, s65, -v55
    v_fma_f32 v25, v25, s65, -v55
    v_fma_f32 v26, v26, s65, -v55
    v_fma_f32 v27, v27, s65, -v55
    v_fma_f32 v28, v28, s65, -v55
    v_fma_f32 v29, v29, s65, -v55
    v_fma_f32 v30, v30, s65, -v55
    v_fma_f32 v31, v31, s65, -v55
    v_fma_f32 v32, v32, s65, -v55
    v_fma_f32 v33, v33, s65, -v55
    v_fma_f32 v34, v34, s65, -v55
    v_fma_f32 v35, v35, s65, -v55
    v_fma_f32 v36, v36, s65, -v55
    v_fma_f32 v37, v37, s65, -v55
    v_fma_f32 v38, v38, s65, -v55
    v_fma_f32 v39, v39, s65, -v55
    v_exp_f32 v24, v24
    v_exp_f32 v25, v25
    v_exp_f32 v26, v26
    v_exp_f32 v27, v27
    v_exp_f32 v28, v28
    v_exp_f32 v29, v29
    v_exp_f32 v30, v30
    v_exp_f32 v31, v31
    v_exp_f32 v32, v32
    v_exp_f32 v33, v33
    v_exp_f32 v34, v34
    v_exp_f32 v35, v35
    v_exp_f32 v36, v36
    v_exp_f32 v37, v37
    v_exp_f32 v38, v38
    v_exp_f32 v39, v39
    v_add_f32 v57, v24, v25
    v_add_f32 v57, v57, v26
    v_add_f32 v57, v57, v27
    v_add_f32 v57, v57, v28
    v_add_f32 v57, v57, v29
    v_add_f32 v57, v57, v30
    v_add_f32 v57, v57, v31
    v_add_f32 v57, v57, v32
    v_add_f32 v57, v57, v33
    v_add_f32 v57, v57, v34
    v_add_f32 v57, v57, v35
    v_add_f32 v57, v57, v36
    v_add_f32 v57, v57, v37
    v_add_f32 v57, v57, v38
    v_add_f32 v57, v57, v39
    v_cvt_pk_bf16_f32 v24, v24, v24
    v_cvt_pk_bf16_f32 v25, v25, v25
    v_cvt_pk_bf16_f32 v26, v26, v26
    v_cvt_pk_bf16_f32 v27, v27, v27
    v_cvt_pk_bf16_f32 v28, v28, v28
    v_cvt_pk_bf16_f32 v29, v29, v29
    v_cvt_pk_bf16_f32 v30, v30, v30
    v_cvt_pk_bf16_f32 v31, v31, v31
    v_cvt_pk_bf16_f32 v32, v32, v32
    v_cvt_pk_bf16_f32 v33, v33, v33
    v_cvt_pk_bf16_f32 v34, v34, v34
    v_cvt_pk_bf16_f32 v35, v35, v35
    v_cvt_pk_bf16_f32 v36, v36, v36
    v_cvt_pk_bf16_f32 v37, v37, v37
    v_cvt_pk_bf16_f32 v38, v38, v38
    v_cvt_pk_bf16_f32 v39, v39, v39
    v_add_f32_dpp v57, v57, v57 row_ror:4 row_mask:0xf bank_mask:0xf
    s_nop 1
    v_add_f32_dpp v57, v57, v57 row_ror:8 row_mask:0xf bank_mask:0xf
    v_mov_b32 v52, v57
    s_nop 1
    v_permlane16_swap_b32 v57, v52
    v_add_f32 v57, v57, v52
    v_mov_b32 v52, v57
    s_nop 1
    v_permlane32_swap_b32 v57, v52
    v_add_f32 v57, v57, v52
    s_mov_b64 exec, 1
    s_lshl_b32 s65, s3, 3
    s_add_u32 s65, s65, 384
    v_mov_b32 v52, s65
    ds_write_b64 v52, v[56:57]
    v_mov_b32 v52, 8
    v_mov_b32 v53, 1
    ds_add_u32 v52, v53
    s_mov_b64 exec, -1
    v_and_b32_dpp v8, v24, v4 row_newbcast:0 row_mask:0xf bank_mask:0xf
    v_and_b32_dpp v9, v24, v5 row_newbcast:0 row_mask:0xf bank_mask:0xf
    v_and_b32_dpp v10, v24, v6 row_newbcast:0 row_mask:0xf bank_mask:0xf
    v_and_b32_dpp v11, v24, v7 row_newbcast:0 row_mask:0xf bank_mask:0xf
    v_and_b32_dpp v12, v24, v4 row_newbcast:4 row_mask:0xf bank_mask:0xf
    v_and_b32_dpp v13, v24, v5 row_newbcast:4 row_mask:0xf bank_mask:0xf
    v_and_b32_dpp v14, v24, v6 row_newbcast:4 row_mask:0xf bank_mask:0xf
    v_and_b32_dpp v15, v24, v7 row_newbcast:4 row_mask:0xf bank_mask:0xf
    s_waitcnt vmcnt(21)
    v_mfma_f32_16x16x32_bf16 v[48:51], a[0:3], v[8:11], 0
    v_and_b32_dpp v8, v24, v4 row_newbcast:8 row_mask:0xf bank_mask:0xf
    v_and_b32_dpp v9, v24, v5 row_newbcast:8 row_mask:0xf bank_mask:0xf
    v_and_b32_dpp v10, v24, v6 row_newbcast:8 row_mask:0xf bank_mask:0xf
    v_and_b32_dpp v11, v24, v7 row_newbcast:8 row_mask:0xf bank_mask:0xf
    s_waitcnt vmcnt(20)
    v_mfma_f32_16x16x32_bf16 v[48:51], a[4:7], v[12:15], v[48:51]
    v_and_b32_dpp v12, v24, v4 row_newbcast:12 row_mask:0xf bank_mask:0xf
    v_and_b32_dpp v13, v24, v5 row_newbcast:12 row_mask:0xf bank_mask:0xf
    v_and_b32_dpp v14, v24, v6 row_newbcast:12 row_mask:0xf bank_mask:0xf
    v_and_b32_dpp v15, v24, v7 row_newbcast:12 row_mask:0xf bank_mask:0xf
    s_waitcnt vmcnt(19)
    v_mfma_f32_16x16x32_bf16 v[48:51], a[8:11], v[8:11], v[48:51]
    v_and_b32_dpp v8, v25, v4 row_newbcast:0 row_mask:0xf bank_mask:0xf
    v_and_b32_dpp v9, v25, v5 row_newbcast:0 row_mask:0xf bank_mask:0xf
    v_and_b32_dpp v10, v25, v6 row_newbcast:0 row_mask:0xf bank_mask:0xf
    v_and_b32_dpp v11, v25, v7 row_newbcast:0 row_mask:0xf bank_mask:0xf
    s_waitcnt vmcnt(18)
    v_mfma_f32_16x16x32_bf16 v[48:51], a[12:15], v[12:15], v[48:51]
    v_and_b32_dpp v12, v25, v4 row_newbcast:4 row_mask:0xf bank_mask:0xf
    v_and_b32_dpp v13, v25, v5 row_newbcast:4 row_mask:0xf bank_mask:0xf
    v_and_b32_dpp v14, v25, v6 row_newbcast:4 row_mask:0xf bank_mask:0xf
    v_and_b32_dpp v15, v25, v7 row_newbcast:4 row_mask:0xf bank_mask:0xf
    s_waitcnt vmcnt(17)
    v_mfma_f32_16x16x32_bf16 v[48:51], a[16:19], v[8:11], v[48:51]
    v_and_b32_dpp v8, v25, v4 row_newbcast:8 row_mask:0xf bank_mask:0xf
    v_and_b32_dpp v9, v25, v5 row_newbcast:8 row_mask:0xf bank_mask:0xf
    v_and_b32_dpp v10, v25, v6 row_newbcast:8 row_mask:0xf bank_mask:0xf
    v_and_b32_dpp v11, v25, v7 row_newbcast:8 row_mask:0xf bank_mask:0xf
    s_waitcnt vmcnt(16)
    v_mfma_f32_16x16x32_bf16 v[48:51], a[20:23], v[12:15], v[48:51]
    v_and_b32_dpp v12, v25, v4 row_newbcast:12 row_mask:0xf bank_mask:0xf
    v_and_b32_dpp v13, v25, v5 row_newbcast:12 row_mask:0xf bank_mask:0xf
    v_and_b32_dpp v14, v25, v6 row_newbcast:12 row_mask:0xf bank_mask:0xf
    v_and_b32_dpp v15, v25, v7 row_newbcast:12 row_mask:0xf bank_mask:0xf
    s_waitcnt vmcnt(15)
    v_mfma_f32_16x16x32_bf16 v[48:51], a[24:27], v[8:11], v[48:51]
    v_and_b32_dpp v8, v26, v4 row_newbcast:0 row_mask:0xf bank_mask:0xf
    v_and_b32_dpp v9, v26, v5 row_newbcast:0 row_mask:0xf bank_mask:0xf
    v_and_b32_dpp v10, v26, v6 row_newbcast:0 row_mask:0xf bank_mask:0xf
    v_and_b32_dpp v11, v26, v7 row_newbcast:0 row_mask:0xf bank_mask:0xf
    s_waitcnt vmcnt(14)
    v_mfma_f32_16x16x32_bf16 v[48:51], a[28:31], v[12:15], v[48:51]
    v_and_b32_dpp v12, v26, v4 row_newbcast:4 row_mask:0xf bank_mask:0xf
    v_and_b32_dpp v13, v26, v5 row_newbcast:4 row_mask:0xf bank_mask:0xf
    v_and_b32_dpp v14, v26, v6 row_newbcast:4 row_mask:0xf bank_mask:0xf
    v_and_b32_dpp v15, v26, v7 row_newbcast:4 row_mask:0xf bank_mask:0xf
    s_waitcnt vmcnt(13)
    v_mfma_f32_16x16x32_bf16 v[48:51], a[32:35], v[8:11], v[48:51]
    v_and_b32_dpp v8, v26, v4 row_newbcast:8 row_mask:0xf bank_mask:0xf
    v_and_b32_dpp v9, v26, v5 row_newbcast:8 row_mask:0xf bank_mask:0xf
    v_and_b32_dpp v10, v26, v6 row_newbcast:8 row_mask:0xf bank_mask:0xf
    v_and_b32_dpp v11, v26, v7 row_newbcast:8 row_mask:0xf bank_mask:0xf
    s_waitcnt vmcnt(12)
    v_mfma_f32_16x16x32_bf16 v[48:51], a[36:39], v[12:15], v[48:51]
    v_and_b32_dpp v12, v26, v4 row_newbcast:12 row_mask:0xf bank_mask:0xf
    v_and_b32_dpp v13, v26, v5 row_newbcast:12 row_mask:0xf bank_mask:0xf
    v_and_b32_dpp v14, v26, v6 row_newbcast:12 row_mask:0xf bank_mask:0xf
    v_and_b32_dpp v15, v26, v7 row_newbcast:12 row_mask:0xf bank_mask:0xf
    s_waitcnt vmcnt(11)
    v_mfma_f32_16x16x32_bf16 v[48:51], a[40:43], v[8:11], v[48:51]
    v_and_b32_dpp v8, v27, v4 row_newbcast:0 row_mask:0xf bank_mask:0xf
    v_and_b32_dpp v9, v27, v5 row_newbcast:0 row_mask:0xf bank_mask:0xf
    v_and_b32_dpp v10, v27, v6 row_newbcast:0 row_mask:0xf bank_mask:0xf
    v_and_b32_dpp v11, v27, v7 row_newbcast:0 row_mask:0xf bank_mask:0xf
    s_waitcnt vmcnt(10)
    v_mfma_f32_16x16x32_bf16 v[48:51], a[44:47], v[12:15], v[48:51]
    v_and_b32_dpp v12, v27, v4 row_newbcast:4 row_mask:0xf bank_mask:0xf
    v_and_b32_dpp v13, v27, v5 row_newbcast:4 row_mask:0xf bank_mask:0xf
    v_and_b32_dpp v14, v27, v6 row_newbcast:4 row_mask:0xf bank_mask:0xf
    v_and_b32_dpp v15, v27, v7 row_newbcast:4 row_mask:0xf bank_mask:0xf
    s_waitcnt vmcnt(9)
    v_mfma_f32_16x16x32_bf16 v[48:51], a[48:51], v[8:11], v[48:51]
    v_mov_b32 v62, 8
    s_mov_b32 s69, 0
Lspin_3:
    ds_read_b32 v61, v62
    s_waitcnt lgkmcnt(0)
    v_readfirstlane_b32 s68, v61
    s_nop 0
    s_cmp_ge_u32 s68, 4
    s_cbranch_scc1 Lspun_4
    s_sleep 1
    s_add_u32 s69, s69, 1
    s_cmp_lt_u32 s69, 800000
    s_cbranch_scc1 Lspin_3
Lspun_4:
    v_mov_b32 v16, 384
    ds_read_b128 v[20:23], v16
    ds_read_b128 v[40:43], v16 offset:16
    s_waitcnt lgkmcnt(0)
    v_max3_f32 v16, v20, v22, v40
    v_max_f32 v16, v16, v42
    s_mov_b32 s65, 0x3fb8aa3b
    v_sub_f32 v58, v56, v16
    v_mul_f32 v58, s65, v58
    v_exp_f32 v58, v58
    s_cmp_lg_u32 s3, 0
    s_cbranch_scc1 Lnoml_5
    v_sub_f32 v20, v20, v16
    v_mul_f32 v20, s65, v20
    v_exp_f32 v20, v20
    v_sub_f32 v22, v22, v16
    v_mul_f32 v22, s65, v22
    v_exp_f32 v22, v22
    v_sub_f32 v40, v40, v16
    v_mul_f32 v40, s65, v40
    v_exp_f32 v40, v40
    v_sub_f32 v42, v42, v16
    v_mul_f32 v42, s65, v42
    v_exp_f32 v42, v42
    v_mul_f32 v17, v20, v21
    v_fmac_f32 v17, v22, v23
    v_fmac_f32 v17, v40, v41
    v_fmac_f32 v17, v42, v43
    v_mov_b32 v18, 0
    v_mov_b32 v19, 0
    v_bfi_b32 v16, s81, v60, v16
    v_bfi_b32 v17, s81, v60, v17
    v_bfi_b32 v18, s81, v60, v18
    v_bfi_b32 v19, s81, v60, v19
    s_mul_i32 s65, s100, 640
    s_add_u32 s65, s65, 66048
    s_mov_b64 exec, 1
    buffer_store_dwordx4 v[16:19], off, s[52:55], s65 sc1
    s_mov_b64 exec, -1
Lnoml_5:
    v_and_b32_dpp v8, v27, v4 row_newbcast:8 row_mask:0xf bank_mask:0xf
    v_and_b32_dpp v9, v27, v5 row_newbcast:8 row_mask:0xf bank_mask:0xf
    v_and_b32_dpp v10, v27, v6 row_newbcast:8 row_mask:0xf bank_mask:0xf
    v_and_b32_dpp v11, v27, v7 row_newbcast:8 row_mask:0xf bank_mask:0xf
    s_waitcnt vmcnt(8)
    v_mfma_f32_16x16x32_bf16 v[48:51], a[52:55], v[12:15], v[48:51]
    v_and_b32_dpp v12, v27, v4 row_newbcast:12 row_mask:0xf bank_mask:0xf
    v_and_b32_dpp v13, v27, v5 row_newbcast:12 row_mask:0xf bank_mask:0xf
    v_and_b32_dpp v14, v27, v6 row_newbcast:12 row_mask:0xf bank_mask:0xf
    v_and_b32_dpp v15, v27, v7 row_newbcast:12 row_mask:0xf bank_mask:0xf
    s_waitcnt vmcnt(7)
    v_mfma_f32_16x16x32_bf16 v[48:51], a[56:59], v[8:11], v[48:51]
    v_and_b32_dpp v8, v28, v4 row_newbcast:0 row_mask:0xf bank_mask:0xf
    v_and_b32_dpp v9, v28, v5 row_newbcast:0 row_mask:0xf bank_mask:0xf
    v_and_b32_dpp v10, v28, v6 row_newbcast:0 row_mask:0xf bank_mask:0xf
    v_and_b32_dpp v11, v28, v7 row_newbcast:0 row_mask:0xf bank_mask:0xf
    s_waitcnt vmcnt(6)
    v_mfma_f32_16x16x32_bf16 v[48:51], a[60:63], v[12:15], v[48:51]
    v_and_b32_dpp v12, v28, v4 row_newbcast:4 row_mask:0xf bank_mask:0xf
    v_and_b32_dpp v13, v28, v5 row_newbcast:4 row_mask:0xf bank_mask:0xf
    v_and_b32_dpp v14, v28, v6 row_newbcast:4 row_mask:0xf bank_mask:0xf
    v_and_b32_dpp v15, v28, v7 row_newbcast:4 row_mask:0xf bank_mask:0xf
    s_waitcnt vmcnt(5)
    v_mfma_f32_16x16x32_bf16 v[48:51], a[64:67], v[8:11], v[48:51]
    v_and_b32_dpp v8, v28, v4 row_newbcast:8 row_mask:0xf bank_mask:0xf
    v_and_b32_dpp v9, v28, v5 row_newbcast:8 row_mask:0xf bank_mask:0xf
    v_and_b32_dpp v10, v28, v6 row_newbcast:8 row_mask:0xf bank_mask:0xf
    v_and_b32_dpp v11, v28, v7 row_newbcast:8 row_mask:0xf bank_mask:0xf
    s_waitcnt vmcnt(4)
    s_mov_b32 s66, 90112
    buffer_load_dwordx4 a[88:91], v2, s[48:51], s66 offen nt
    s_waitcnt vmcnt(5)
    v_mfma_f32_16x16x32_bf16 v[48:51], a[68:71], v[12:15], v[48:51]
    v_and_b32_dpp v12, v28, v4 row_newbcast:12 row_mask:0xf bank_mask:0xf
    v_and_b32_dpp v13, v28, v5 row_newbcast:12 row_mask:0xf bank_mask:0xf
    v_and_b32_dpp v14, v28, v6 row_newbcast:12 row_mask:0xf bank_mask:0xf
    v_and_b32_dpp v15, v28, v7 row_newbcast:12 row_mask:0xf bank_mask:0xf
    s_waitcnt vmcnt(4)
    s_mov_b32 s66, 94208
    buffer_load_dwordx4 a[92:95], v2, s[48:51], s66 offen nt
    s_waitcnt vmcnt(5)
    v_mfma_f32_16x16x32_bf16 v[48:51], a[72:75], v[8:11], v[48:51]
    v_and_b32_dpp v8, v29, v4 row_newbcast:0 row_mask:0xf bank_mask:0xf
    v_and_b32_dpp v9, v29, v5 row_newbcast:0 row_mask:0xf bank_mask:0xf
    v_and_b32_dpp v10, v29, v6 row_newbcast:0 row_mask:0xf bank_mask:0xf
    v_and_b32_dpp v11, v29, v7 row_newbcast:0 row_mask:0xf bank_mask:0xf
    s_waitcnt vmcnt(4)
    s_mov_b32 s66, 98304
    buffer_load_dwordx4 a[96:99], v2, s[48:51], s66 offen nt
    s_waitcnt vmcnt(5)
    v_mfma_f32_16x16x32_bf16 v[48:51], a[76:79], v[12:15], v[48:51]
    v_and_b32_dpp v12, v29, v4 row_newbcast:4 row_mask:0xf bank_mask:0xf
    v_and_b32_dpp v13, v29, v5 row_newbcast:4 row_mask:0xf bank_mask:0xf
    v_and_b32_dpp v14, v29, v6 row_newbcast:4 row_mask:0xf bank_mask:0xf
    v_and_b32_dpp v15, v29, v7 row_newbcast:4 row_mask:0xf bank_mask:0xf
    s_waitcnt vmcnt(4)
    s_mov_b32 s66, 102400
    buffer_load_dwordx4 a[100:103], v2, s[48:51], s66 offen nt
    s_waitcnt vmcnt(5)
    v_mfma_f32_16x16x32_bf16 v[48:51], a[80:83], v[8:11], v[48:51]
    v_and_b32_dpp v8, v29, v4 row_newbcast:8 row_mask:0xf bank_mask:0xf
    v_and_b32_dpp v9, v29, v5 row_newbcast:8 row_mask:0xf bank_mask:0xf
    v_and_b32_dpp v10, v29, v6 row_newbcast:8 row_mask:0xf bank_mask:0xf
    v_and_b32_dpp v11, v29, v7 row_newbcast:8 row_mask:0xf bank_mask:0xf
    s_waitcnt vmcnt(4)
    s_mov_b32 s66, 106496
    buffer_load_dwordx4 a[104:107], v2, s[48:51], s66 offen nt
    s_waitcnt vmcnt(5)
    v_mfma_f32_16x16x32_bf16 v[48:51], a[84:87], v[12:15], v[48:51]
    v_and_b32_dpp v12, v29, v4 row_newbcast:12 row_mask:0xf bank_mask:0xf
    v_and_b32_dpp v13, v29, v5 row_newbcast:12 row_mask:0xf bank_mask:0xf
    v_and_b32_dpp v14, v29, v6 row_newbcast:12 row_mask:0xf bank_mask:0xf
    v_and_b32_dpp v15, v29, v7 row_newbcast:12 row_mask:0xf bank_mask:0xf
    s_waitcnt vmcnt(4)
    s_mov_b32 s66, 110592
    buffer_load_dwordx4 a[108:111], v2, s[48:51], s66 offen nt
    s_waitcnt vmcnt(5)
    v_mfma_f32_16x16x32_bf16 v[48:51], a[88:91], v[8:11], v[48:51]
    v_and_b32_dpp v8, v30, v4 row_newbcast:0 row_mask:0xf bank_mask:0xf
    v_and_b32_dpp v9, v30, v5 row_newbcast:0 row_mask:0xf bank_mask:0xf
    v_and_b32_dpp v10, v30, v6 row_newbcast:0 row_mask:0xf bank_mask:0xf
    v_and_b32_dpp v11, v30, v7 row_newbcast:0 row_mask:0xf bank_mask:0xf
    s_waitcnt vmcnt(4)
    s_mov_b32 s66, 114688
    buffer_load_dwordx4 a[112:115], v2, s[48:51], s66 offen nt
    s_waitcnt vmcnt(5)
    v_mfma_f32_16x16x32_bf16 v[48:51], a[92:95], v[12:15], v[48:51]
    v_and_b32_dpp v12, v30, v4 row_newbcast:4 row_mask:0xf bank_mask:0xf
    v_and_b32_dpp v13, v30, v5 row_newbcast:4 row_mask:0xf bank_mask:0xf
    v_and_b32_dpp v14, v30, v6 row_newbcast:4 row_mask:0xf bank_mask:0xf
    v_and_b32_dpp v15, v30, v7 row_newbcast:4 row_mask:0xf bank_mask:0xf
    s_waitcnt vmcnt(4)
    s_mov_b32 s66, 118784
    buffer_load_dwordx4 a[116:119], v2, s[48:51], s66 offen nt
    s_waitcnt vmcnt(5)
    v_mfma_f32_16x16x32_bf16 v[48:51], a[96:99], v[8:11], v[48:51]
    v_and_b32_dpp v8, v30, v4 row_newbcast:8 row_mask:0xf bank_mask:0xf
    v_and_b32_dpp v9, v30, v5 row_newbcast:8 row_mask:0xf bank_mask:0xf
    v_and_b32_dpp v10, v30, v6 row_newbcast:8 row_mask:0xf bank_mask:0xf
    v_and_b32_dpp v11, v30, v7 row_newbcast:8 row_mask:0xf bank_mask:0xf
    s_waitcnt vmcnt(4)
    s_mov_b32 s66, 122880
    buffer_load_dwordx4 a[120:123], v2, s[48:51], s66 offen nt
    s_waitcnt vmcnt(5)
    v_mfma_f32_16x16x32_bf16 v[48:51], a[100:103], v[12:15], v[48:51]
    v_and_b32_dpp v12, v30, v4 row_newbcast:12 row_mask:0xf bank_mask:0xf
    v_and_b32_dpp v13, v30, v5 row_newbcast:12 row_mask:0xf bank_mask:0xf
    v_and_b32_dpp v14, v30, v6 row_newbcast:12 row_mask:0xf bank_mask:0xf
    v_and_b32_dpp v15, v30, v7 row_newbcast:12 row_mask:0xf bank_mask:0xf
    s_waitcnt vmcnt(4)
    s_mov_b32 s66, 126976
    buffer_load_dwordx4 a[124:127], v2, s[48:51], s66 offen nt
    s_waitcnt vmcnt(9)
    s_mov_b32 s66, 131072
    buffer_load_dwordx4 a[128:131], v2, s[48:51], s66 offen nt
    s_waitcnt vmcnt(9)
    s_mov_b32 s66, 135168
    buffer_load_dwordx4 a[132:135], v2, s[48:51], s66 offen nt
    s_waitcnt vmcnt(9)
    s_mov_b32 s66, 139264
    buffer_load_dwordx4 a[136:139], v2, s[48:51], s66 offen nt
    s_waitcnt vmcnt(9)
    s_mov_b32 s66, 143360
    buffer_load_dwordx4 a[140:143], v2, s[48:51], s66 offen nt
    s_waitcnt vmcnt(9)
    s_mov_b32 s66, 147456
    buffer_load_dwordx4 a[144:147], v2, s[48:51], s66 offen nt
    s_waitcnt vmcnt(10)
    v_mfma_f32_16x16x32_bf16 v[48:51], a[104:107], v[8:11], v[48:51]
    v_and_b32_dpp v8, v31, v4 row_newbcast:0 row_mask:0xf bank_mask:0xf
    v_and_b32_dpp v9, v31, v5 row_newbcast:0 row_mask:0xf bank_mask:0xf
    v_and_b32_dpp v10, v31, v6 row_newbcast:0 row_mask:0xf bank_mask:0xf
    v_and_b32_dpp v11, v31, v7 row_newbcast:0 row_mask:0xf bank_mask:0xf
    s_waitcnt vmcnt(9)
    s_mov_b32 s66, 151552
    buffer_load_dwordx4 a[148:151], v2, s[48:51], s66 offen nt
    s_waitcnt vmcnt(10)
    v_mfma_f32_16x16x32_bf16 v[48:51], a[108:111], v[12:15], v[48:51]
    v_and_b32_dpp v12, v31, v4 row_newbcast:4 row_mask:0xf bank_mask:0xf
    v_and_b32_dpp v13, v31, v5 row_newbcast:4 row_mask:0xf bank_mask:0xf
    v_and_b32_dpp v14, v31, v6 row_newbcast:4 row_mask:0xf bank_mask:0xf
    v_and_b32_dpp v15, v31, v7 row_newbcast:4 row_mask:0xf bank_mask:0xf
    s_waitcnt vmcnt(9)
    s_mov_b32 s66, 155648
    buffer_load_dwordx4 a[152:155], v2, s[48:51], s66 offen nt
    s_waitcnt vmcnt(10)
    v_mfma_f32_16x16x32_bf16 v[48:51], a[112:115], v[8:11], v[48:51]
    v_and_b32_dpp v8, v31, v4 row_newbcast:8 row_mask:0xf bank_mask:0xf
    v_and_b32_dpp v9, v31, v5 row_newbcast:8 row_mask:0xf bank_mask:0xf
    v_and_b32_dpp v10, v31, v6 row_newbcast:8 row_mask:0xf bank_mask:0xf
    v_and_b32_dpp v11, v31, v7 row_newbcast:8 row_mask:0xf bank_mask:0xf
    s_waitcnt vmcnt(9)
    s_mov_b32 s66, 159744
    buffer_load_dwordx4 a[156:159], v2, s[48:51], s66 offen nt
    s_waitcnt vmcnt(10)
    v_mfma_f32_16x16x32_bf16 v[48:51], a[116:119], v[12:15], v[48:51]
    v_and_b32_dpp v12, v31, v4 row_newbcast:12 row_mask:0xf bank_mask:0xf
    v_and_b32_dpp v13, v31, v5 row_newbcast:12 row_mask:0xf bank_mask:0xf
    v_and_b32_dpp v14, v31, v6 row_newbcast:12 row_mask:0xf bank_mask:0xf
    v_and_b32_dpp v15, v31, v7 row_newbcast:12 row_mask:0xf bank_mask:0xf
    s_waitcnt vmcnt(9)
    s_mov_b32 s66, 163840
    buffer_load_dwordx4 a[0:3], v2, s[48:51], s66 offen nt
    s_waitcnt vmcnt(10)
    v_mfma_f32_16x16x32_bf16 v[48:51], a[120:123], v[8:11], v[48:51]
    v_and_b32_dpp v8, v32, v4 row_newbcast:0 row_mask:0xf bank_mask:0xf
    v_and_b32_dpp v9, v32, v5 row_newbcast:0 row_mask:0xf bank_mask:0xf
    v_and_b32_dpp v10, v32, v6 row_newbcast:0 row_mask:0xf bank_mask:0xf
    v_and_b32_dpp v11, v32, v7 row_newbcast:0 row_mask:0xf bank_mask:0xf
    s_waitcnt vmcnt(9)
    s_mov_b32 s66, 167936
    buffer_load_dwordx4 a[4:7], v2, s[48:51], s66 offen nt
    s_waitcnt vmcnt(10)
    v_mfma_f32_16x16x32_bf16 v[48:51], a[124:127], v[12:15], v[48:51]
    v_and_b32_dpp v12, v32, v4 row_newbcast:4 row_mask:0xf bank_mask:0xf
    v_and_b32_dpp v13, v32, v5 row_newbcast:4 row_mask:0xf bank_mask:0xf
    v_and_b32_dpp v14, v32, v6 row_newbcast:4 row_mask:0xf bank_mask:0xf
    v_and_b32_dpp v15, v32, v7 row_newbcast:4 row_mask:0xf bank_mask:0xf
    s_waitcnt vmcnt(9)
    s_mov_b32 s66, 172032
    buffer_load_dwordx4 a[8:11], v2, s[48:51], s66 offen nt
    s_waitcnt vmcnt(10)
    v_mfma_f32_16x16x32_bf16 v[48:51], a[128:131], v[8:11], v[48:51]
    v_and_b32_dpp v8, v32, v4 row_newbcast:8 row_mask:0xf bank_mask:0xf
    v_and_b32_dpp v9, v32, v5 row_newbcast:8 row_mask:0xf bank_mask:0xf
    v_and_b32_dpp v10, v32, v6 row_newbcast:8 row_mask:0xf bank_mask:0xf
    v_and_b32_dpp v11, v32, v7 row_newbcast:8 row_mask:0xf bank_mask:0xf
    s_waitcnt vmcnt(9)
    s_mov_b32 s66, 176128
    buffer_load_dwordx4 a[12:15], v2, s[48:51], s66 offen nt
    s_waitcnt vmcnt(10)
    v_mfma_f32_16x16x32_bf16 v[48:51], a[132:135], v[12:15], v[48:51]
    v_and_b32_dpp v12, v32, v4 row_newbcast:12 row_mask:0xf bank_mask:0xf
    v_and_b32_dpp v13, v32, v5 row_newbcast:12 row_mask:0xf bank_mask:0xf
    v_and_b32_dpp v14, v32, v6 row_newbcast:12 row_mask:0xf bank_mask:0xf
    v_and_b32_dpp v15, v32, v7 row_newbcast:12 row_mask:0xf bank_mask:0xf
    s_waitcnt vmcnt(9)
    s_mov_b32 s66, 180224
    buffer_load_dwordx4 a[16:19], v2, s[48:51], s66 offen nt
    s_waitcnt vmcnt(10)
    v_mfma_f32_16x16x32_bf16 v[48:51], a[136:139], v[8:11], v[48:51]
    v_and_b32_dpp v8, v33, v4 row_newbcast:0 row_mask:0xf bank_mask:0xf
    v_and_b32_dpp v9, v33, v5 row_newbcast:0 row_mask:0xf bank_mask:0xf
    v_and_b32_dpp v10, v33, v6 row_newbcast:0 row_mask:0xf bank_mask:0xf
    v_and_b32_dpp v11, v33, v7 row_newbcast:0 row_mask:0xf bank_mask:0xf
    s_waitcnt vmcnt(9)
    s_mov_b32 s66, 184320
    buffer_load_dwordx4 a[20:23], v2, s[48:51], s66 offen nt
    s_waitcnt vmcnt(10)
    v_mfma_f32_16x16x32_bf16 v[48:51], a[140:143], v[12:15], v[48:51]
    v_and_b32_dpp v12, v33, v4 row_newbcast:4 row_mask:0xf bank_mask:0xf
    v_and_b32_dpp v13, v33, v5 row_newbcast:4 row_mask:0xf bank_mask:0xf
    v_and_b32_dpp v14, v33, v6 row_newbcast:4 row_mask:0xf bank_mask:0xf
    v_and_b32_dpp v15, v33, v7 row_newbcast:4 row_mask:0xf bank_mask:0xf
    s_waitcnt vmcnt(9)
    s_mov_b32 s66, 188416
    buffer_load_dwordx4 a[24:27], v2, s[48:51], s66 offen nt
    s_waitcnt vmcnt(10)
    v_mfma_f32_16x16x32_bf16 v[48:51], a[144:147], v[8:11], v[48:51]
    v_and_b32_dpp v8, v33, v4 row_newbcast:8 row_mask:0xf bank_mask:0xf
    v_and_b32_dpp v9, v33, v5 row_newbcast:8 row_mask:0xf bank_mask:0xf
    v_and_b32_dpp v10, v33, v6 row_newbcast:8 row_mask:0xf bank_mask:0xf
    v_and_b32_dpp v11, v33, v7 row_newbcast:8 row_mask:0xf bank_mask:0xf
    s_waitcnt vmcnt(9)
    s_mov_b32 s66, 192512
    buffer_load_dwordx4 a[28:31], v2, s[48:51], s66 offen nt
    s_waitcnt vmcnt(10)
    v_mfma_f32_16x16x32_bf16 v[48:51], a[148:151], v[12:15], v[48:51]
    v_and_b32_dpp v12, v33, v4 row_newbcast:12 row_mask:0xf bank_mask:0xf
    v_and_b32_dpp v13, v33, v5 row_newbcast:12 row_mask:0xf bank_mask:0xf
    v_and_b32_dpp v14, v33, v6 row_newbcast:12 row_mask:0xf bank_mask:0xf
    v_and_b32_dpp v15, v33, v7 row_newbcast:12 row_mask:0xf bank_mask:0xf
    s_waitcnt vmcnt(9)
    s_mov_b32 s66, 196608
    buffer_load_dwordx4 a[32:35], v2, s[48:51], s66 offen nt
    s_waitcnt vmcnt(10)
    v_mfma_f32_16x16x32_bf16 v[48:51], a[152:155], v[8:11], v[48:51]
    v_and_b32_dpp v8, v34, v4 row_newbcast:0 row_mask:0xf bank_mask:0xf
    v_and_b32_dpp v9, v34, v5 row_newbcast:0 row_mask:0xf bank_mask:0xf
    v_and_b32_dpp v10, v34, v6 row_newbcast:0 row_mask:0xf bank_mask:0xf
    v_and_b32_dpp v11, v34, v7 row_newbcast:0 row_mask:0xf bank_mask:0xf
    s_waitcnt vmcnt(9)
    s_mov_b32 s66, 200704
    buffer_load_dwordx4 a[36:39], v2, s[48:51], s66 offen nt
    s_waitcnt vmcnt(10)
    v_mfma_f32_16x16x32_bf16 v[48:51], a[156:159], v[12:15], v[48:51]
    v_and_b32_dpp v12, v34, v4 row_newbcast:4 row_mask:0xf bank_mask:0xf
    v_and_b32_dpp v13, v34, v5 row_newbcast:4 row_mask:0xf bank_mask:0xf
    v_and_b32_dpp v14, v34, v6 row_newbcast:4 row_mask:0xf bank_mask:0xf
    v_and_b32_dpp v15, v34, v7 row_newbcast:4 row_mask:0xf bank_mask:0xf
    s_waitcnt vmcnt(9)
    s_mov_b32 s66, 204800
    buffer_load_dwordx4 a[40:43], v2, s[48:51], s66 offen nt
    s_waitcnt vmcnt(10)
    v_mfma_f32_16x16x32_bf16 v[48:51], a[0:3], v[8:11], v[48:51]
    v_and_b32_dpp v8, v34, v4 row_newbcast:8 row_mask:0xf bank_mask:0xf
    v_and_b32_dpp v9, v34, v5 row_newbcast:8 row_mask:0xf bank_mask:0xf
    v_and_b32_dpp v10, v34, v6 row_newbcast:8 row_mask:0xf bank_mask:0xf
    v_and_b32_dpp v11, v34, v7 row_newbcast:8 row_mask:0xf bank_mask:0xf
    s_waitcnt vmcnt(9)
    s_mov_b32 s66, 208896
    buffer_load_dwordx4 a[44:47], v2, s[48:51], s66 offen nt
    s_waitcnt vmcnt(10)
    v_mfma_f32_16x16x32_bf16 v[48:51], a[4:7], v[12:15], v[48:51]
    v_and_b32_dpp v12, v34, v4 row_newbcast:12 row_mask:0xf bank_mask:0xf
    v_and_b32_dpp v13, v34, v5 row_newbcast:12 row_mask:0xf bank_mask:0xf
    v_and_b32_dpp v14, v34, v6 row_newbcast:12 row_mask:0xf bank_mask:0xf
    v_and_b32_dpp v15, v34, v7 row_newbcast:12 row_mask:0xf bank_mask:0xf
    s_waitcnt vmcnt(9)
    s_mov_b32 s66, 212992
    buffer_load_dwordx4 a[48:51], v2, s[48:51], s66 offen nt
    s_waitcnt vmcnt(10)
    v_mfma_f32_16x16x32_bf16 v[48:51], a[8:11], v[8:11], v[48:51]
    v_and_b32_dpp v8, v35, v4 row_newbcast:0 row_mask:0xf bank_mask:0xf
    v_and_b32_dpp v9, v35, v5 row_newbcast:0 row_mask:0xf bank_mask:0xf
    v_and_b32_dpp v10, v35, v6 row_newbcast:0 row_mask:0xf bank_mask:0xf
    v_and_b32_dpp v11, v35, v7 row_newbcast:0 row_mask:0xf bank_mask:0xf
    s_waitcnt vmcnt(9)
    s_mov_b32 s66, 217088
    buffer_load_dwordx4 a[52:55], v2, s[48:51], s66 offen nt
    s_waitcnt vmcnt(10)
    v_mfma_f32_16x16x32_bf16 v[48:51], a[12:15], v[12:15], v[48:51]
    v_and_b32_dpp v12, v35, v4 row_newbcast:4 row_mask:0xf bank_mask:0xf
    v_and_b32_dpp v13, v35, v5 row_newbcast:4 row_mask:0xf bank_mask:0xf
    v_and_b32_dpp v14, v35, v6 row_newbcast:4 row_mask:0xf bank_mask:0xf
    v_and_b32_dpp v15, v35, v7 row_newbcast:4 row_mask:0xf bank_mask:0xf
    s_waitcnt vmcnt(9)
    s_mov_b32 s66, 221184
    buffer_load_dwordx4 a[56:59], v2, s[48:51], s66 offen nt
    s_waitcnt vmcnt(10)
    v_mfma_f32_16x16x32_bf16 v[48:51], a[16:19], v[8:11], v[48:51]
    v_and_b32_dpp v8, v35, v4 row_newbcast:8 row_mask:0xf bank_mask:0xf
    v_and_b32_dpp v9, v35, v5 row_newbcast:8 row_mask:0xf bank_mask:0xf
    v_and_b32_dpp v10, v35, v6 row_newbcast:8 row_mask:0xf bank_mask:0xf
    v_and_b32_dpp v11, v35, v7 row_newbcast:8 row_mask:0xf bank_mask:0xf
    s_waitcnt vmcnt(9)
    s_mov_b32 s66, 225280
    buffer_load_dwordx4 a[60:63], v2, s[48:51], s66 offen nt
    s_waitcnt vmcnt(10)
    v_mfma_f32_16x16x32_bf16 v[48:51], a[20:23], v[12:15], v[48:51]
    v_and_b32_dpp v12, v35, v4 row_newbcast:12 row_mask:0xf bank_mask:0xf
    v_and_b32_dpp v13, v35, v5 row_newbcast:12 row_mask:0xf bank_mask:0xf
    v_and_b32_dpp v14, v35, v6 row_newbcast:12 row_mask:0xf bank_mask:0xf
    v_and_b32_dpp v15, v35, v7 row_newbcast:12 row_mask:0xf bank_mask:0xf
    s_waitcnt vmcnt(9)
    s_mov_b32 s66, 229376
    buffer_load_dwordx4 a[64:67], v2, s[48:51], s66 offen nt
    s_waitcnt vmcnt(10)
    v_mfma_f32_16x16x32_bf16 v[48:51], a[24:27], v[8:11], v[48:51]
    v_and_b32_dpp v8, v36, v4 row_newbcast:0 row_mask:0xf bank_mask:0xf
    v_and_b32_dpp v9, v36, v5 row_newbcast:0 row_mask:0xf bank_mask:0xf
    v_and_b32_dpp v10, v36, v6 row_newbcast:0 row_mask:0xf bank_mask:0xf
    v_and_b32_dpp v11, v36, v7 row_newbcast:0 row_mask:0xf bank_mask:0xf
    s_waitcnt vmcnt(9)
    s_mov_b32 s66, 233472
    buffer_load_dwordx4 a[68:71], v2, s[48:51], s66 offen nt
    s_waitcnt vmcnt(10)
    v_mfma_f32_16x16x32_bf16 v[48:51], a[28:31], v[12:15], v[48:51]
    v_and_b32_dpp v12, v36, v4 row_newbcast:4 row_mask:0xf bank_mask:0xf
    v_and_b32_dpp v13, v36, v5 row_newbcast:4 row_mask:0xf bank_mask:0xf
    v_and_b32_dpp v14, v36, v6 row_newbcast:4 row_mask:0xf bank_mask:0xf
    v_and_b32_dpp v15, v36, v7 row_newbcast:4 row_mask:0xf bank_mask:0xf
    s_waitcnt vmcnt(9)
    s_mov_b32 s66, 237568
    buffer_load_dwordx4 a[72:75], v2, s[48:51], s66 offen nt
    s_waitcnt vmcnt(10)
    v_mfma_f32_16x16x32_bf16 v[48:51], a[32:35], v[8:11], v[48:51]
    v_and_b32_dpp v8, v36, v4 row_newbcast:8 row_mask:0xf bank_mask:0xf
    v_and_b32_dpp v9, v36, v5 row_newbcast:8 row_mask:0xf bank_mask:0xf
    v_and_b32_dpp v10, v36, v6 row_newbcast:8 row_mask:0xf bank_mask:0xf
    v_and_b32_dpp v11, v36, v7 row_newbcast:8 row_mask:0xf bank_mask:0xf
    s_waitcnt vmcnt(9)
    s_mov_b32 s66, 241664
    buffer_load_dwordx4 a[76:79], v2, s[48:51], s66 offen nt
    s_waitcnt vmcnt(10)
    v_mfma_f32_16x16x32_bf16 v[48:51], a[36:39], v[12:15], v[48:51]
    v_and_b32_dpp v12, v36, v4 row_newbcast:12 row_mask:0xf bank_mask:0xf
    v_and_b32_dpp v13, v36, v5 row_newbcast:12 row_mask:0xf bank_mask:0xf
    v_and_b32_dpp v14, v36, v6 row_newbcast:12 row_mask:0xf bank_mask:0xf
    v_and_b32_dpp v15, v36, v7 row_newbcast:12 row_mask:0xf bank_mask:0xf
    s_waitcnt vmcnt(9)
    s_mov_b32 s66, 245760
    buffer_load_dwordx4 a[80:83], v2, s[48:51], s66 offen nt
    s_waitcnt vmcnt(10)
    v_mfma_f32_16x16x32_bf16 v[48:51], a[40:43], v[8:11], v[48:51]
    v_and_b32_dpp v8, v37, v4 row_newbcast:0 row_mask:0xf bank_mask:0xf
    v_and_b32_dpp v9, v37, v5 row_newbcast:0 row_mask:0xf bank_mask:0xf
    v_and_b32_dpp v10, v37, v6 row_newbcast:0 row_mask:0xf bank_mask:0xf
    v_and_b32_dpp v11, v37, v7 row_newbcast:0 row_mask:0xf bank_mask:0xf
    s_waitcnt vmcnt(9)
    s_mov_b32 s66, 249856
    buffer_load_dwordx4 a[84:87], v2, s[48:51], s66 offen nt
    s_waitcnt vmcnt(10)
    v_mfma_f32_16x16x32_bf16 v[48:51], a[44:47], v[12:15], v[48:51]
    v_and_b32_dpp v12, v37, v4 row_newbcast:4 row_mask:0xf bank_mask:0xf
    v_and_b32_dpp v13, v37, v5 row_newbcast:4 row_mask:0xf bank_mask:0xf
    v_and_b32_dpp v14, v37, v6 row_newbcast:4 row_mask:0xf bank_mask:0xf
    v_and_b32_dpp v15, v37, v7 row_newbcast:4 row_mask:0xf bank_mask:0xf
    s_waitcnt vmcnt(9)
    s_mov_b32 s66, 253952
    buffer_load_dwordx4 a[88:91], v2, s[48:51], s66 offen nt
    s_waitcnt vmcnt(10)
    v_mfma_f32_16x16x32_bf16 v[48:51], a[48:51], v[8:11], v[48:51]
    v_and_b32_dpp v8, v37, v4 row_newbcast:8 row_mask:0xf bank_mask:0xf
    v_and_b32_dpp v9, v37, v5 row_newbcast:8 row_mask:0xf bank_mask:0xf
    v_and_b32_dpp v10, v37, v6 row_newbcast:8 row_mask:0xf bank_mask:0xf
    v_and_b32_dpp v11, v37, v7 row_newbcast:8 row_mask:0xf bank_mask:0xf
    s_waitcnt vmcnt(9)
    s_mov_b32 s66, 258048
    buffer_load_dwordx4 a[92:95], v2, s[48:51], s66 offen nt
    s_mov_b64 exec, 1
    v_mov_b32 v52, 4
    v_mov_b32 v53, 1
    ds_add_u32 v52, v53
    s_mov_b64 exec, -1
    s_waitcnt vmcnt(10)
    v_mfma_f32_16x16x32_bf16 v[48:51], a[52:55], v[12:15], v[48:51]
    v_and_b32_dpp v12, v37, v4 row_newbcast:12 row_mask:0xf bank_mask:0xf
    v_and_b32_dpp v13, v37, v5 row_newbcast:12 row_mask:0xf bank_mask:0xf
    v_and_b32_dpp v14, v37, v6 row_newbcast:12 row_mask:0xf bank_mask:0xf
    v_and_b32_dpp v15, v37, v7 row_newbcast:12 row_mask:0xf bank_mask:0xf
    s_waitcnt vmcnt(9)
    v_mfma_f32_16x16x32_bf16 v[48:51], a[56:59], v[8:11], v[48:51]
    v_and_b32_dpp v8, v38, v4 row_newbcast:0 row_mask:0xf bank_mask:0xf
    v_and_b32_dpp v9, v38, v5 row_newbcast:0 row_mask:0xf bank_mask:0xf
    v_and_b32_dpp v10, v38, v6 row_newbcast:0 row_mask:0xf bank_mask:0xf
    v_and_b32_dpp v11, v38, v7 row_newbcast:0 row_mask:0xf bank_mask:0xf
    s_waitcnt vmcnt(8)
    v_mfma_f32_16x16x32_bf16 v[48:51], a[60:63], v[12:15], v[48:51]
    v_and_b32_dpp v12, v38, v4 row_newbcast:4 row_mask:0xf bank_mask:0xf
    v_and_b32_dpp v13, v38, v5 row_newbcast:4 row_mask:0xf bank_mask:0xf
    v_and_b32_dpp v14, v38, v6 row_newbcast:4 row_mask:0xf bank_mask:0xf
    v_and_b32_dpp v15, v38, v7 row_newbcast:4 row_mask:0xf bank_mask:0xf
    s_waitcnt vmcnt(7)
    v_mfma_f32_16x16x32_bf16 v[48:51], a[64:67], v[8:11], v[48:51]
    v_and_b32_dpp v8, v38, v4 row_newbcast:8 row_mask:0xf bank_mask:0xf
    v_and_b32_dpp v9, v38, v5 row_newbcast:8 row_mask:0xf bank_mask:0xf
    v_and_b32_dpp v10, v38, v6 row_newbcast:8 row_mask:0xf bank_mask:0xf
    v_and_b32_dpp v11, v38, v7 row_newbcast:8 row_mask:0xf bank_mask:0xf
    s_waitcnt vmcnt(6)
    v_mfma_f32_16x16x32_bf16 v[48:51], a[68:71], v[12:15], v[48:51]
    v_and_b32_dpp v12, v38, v4 row_newbcast:12 row_mask:0xf bank_mask:0xf
    v_and_b32_dpp v13, v38, v5 row_newbcast:12 row_mask:0xf bank_mask:0xf
    v_and_b32_dpp v14, v38, v6 row_newbcast:12 row_mask:0xf bank_mask:0xf
    v_and_b32_dpp v15, v38, v7 row_newbcast:12 row_mask:0xf bank_mask:0xf
    s_waitcnt vmcnt(5)
    v_mfma_f32_16x16x32_bf16 v[48:51], a[72:75], v[8:11], v[48:51]
    v_and_b32_dpp v8, v39, v4 row_newbcast:0 row_mask:0xf bank_mask:0xf
    v_and_b32_dpp v9, v39, v5 row_newbcast:0 row_mask:0xf bank_mask:0xf
    v_and_b32_dpp v10, v39, v6 row_newbcast:0 row_mask:0xf bank_mask:0xf
    v_and_b32_dpp v11, v39, v7 row_newbcast:0 row_mask:0xf bank_mask:0xf
    s_waitcnt vmcnt(4)
    v_mfma_f32_16x16x32_bf16 v[48:51], a[76:79], v[12:15], v[48:51]
    v_and_b32_dpp v12, v39, v4 row_newbcast:4 row_mask:0xf bank_mask:0xf
    v_and_b32_dpp v13, v39, v5 row_newbcast:4 row_mask:0xf bank_mask:0xf
    v_and_b32_dpp v14, v39, v6 row_newbcast:4 row_mask:0xf bank_mask:0xf
    v_and_b32_dpp v15, v39, v7 row_newbcast:4 row_mask:0xf bank_mask:0xf
    s_waitcnt vmcnt(3)
    v_mfma_f32_16x16x32_bf16 v[48:51], a[80:83], v[8:11], v[48:51]
    v_and_b32_dpp v8, v39, v4 row_newbcast:8 row_mask:0xf bank_mask:0xf
    v_and_b32_dpp v9, v39, v5 row_newbcast:8 row_mask:0xf bank_mask:0xf
    v_and_b32_dpp v10, v39, v6 row_newbcast:8 row_mask:0xf bank_mask:0xf
    v_and_b32_dpp v11, v39, v7 row_newbcast:8 row_mask:0xf bank_mask:0xf
    s_waitcnt vmcnt(2)
    v_mfma_f32_16x16x32_bf16 v[48:51], a[84:87], v[12:15], v[48:51]
    v_and_b32_dpp v12, v39, v4 row_newbcast:12 row_mask:0xf bank_mask:0xf
    v_and_b32_dpp v13, v39, v5 row_newbcast:12 row_mask:0xf bank_mask:0xf
    v_and_b32_dpp v14, v39, v6 row_newbcast:12 row_mask:0xf bank_mask:0xf
    v_and_b32_dpp v15, v39, v7 row_newbcast:12 row_mask:0xf bank_mask:0xf
    s_waitcnt vmcnt(1)
    v_mfma_f32_16x16x32_bf16 v[48:51], a[88:91], v[8:11], v[48:51]
    s_waitcnt vmcnt(0)
    v_mfma_f32_16x16x32_bf16 v[48:51], a[92:95], v[12:15], v[48:51]
    s_nop 7
    v_mul_f32 v48, v58, v48
    v_mul_f32 v49, v58, v49
    v_mul_f32 v50, v58, v50
    v_mul_f32 v51, v58, v51
    s_mov_b32 exec_lo, 0x00ff00ff
    s_mov_b32 exec_hi, 0x00ff00ff
    ds_write_b32 v64, v48 offset:0
    ds_write_b32 v64, v49 offset:32
    ds_write_b32 v64, v50 offset:64
    ds_write_b32 v64, v51 offset:96
    s_mov_b64 exec, 1
    v_mov_b32 v8, 12
    v_mov_b32 v9, 1
    ds_add_rtn_u32 v9, v8, v9
    s_mul_i32 s65, s100, 640
    s_add_u32 s65, s65, 65536
    s_waitcnt lgkmcnt(0)
    v_readfirstlane_b32 s66, v9
    s_nop 0
    s_cmp_lg_u32 s66, 3
    s_cbranch_scc1 L_sdone
    s_mov_b32 exec_lo, 0xffffffff
    s_mov_b32 exec_hi, 0x00000000
    ds_read_b128 v[12:15], v65 offset:6144
    ds_read_b128 v[16:19], v65 offset:6656
    ds_read_b128 v[20:23], v65 offset:7168
    ds_read_b128 v[24:27], v65 offset:7680
    s_waitcnt lgkmcnt(0)
    v_pk_add_f32 v[12:13], v[12:13], v[16:17]
    v_pk_add_f32 v[14:15], v[14:15], v[18:19]
    v_pk_add_f32 v[20:21], v[20:21], v[24:25]
    v_pk_add_f32 v[22:23], v[22:23], v[26:27]
    v_pk_add_f32 v[12:13], v[12:13], v[20:21]
    v_pk_add_f32 v[14:15], v[14:15], v[22:23]
    v_bfi_b32 v12, s81, v60, v12
    v_bfi_b32 v13, s81, v60, v13
    v_bfi_b32 v14, s81, v60, v14
    v_bfi_b32 v15, s81, v60, v15
    buffer_store_dwordx4 v[12:15], v65, s[52:55], s65 offen sc1
L_sdone:
    s_endpgm
L_helper:
    s_load_dword s64, s[42:43], 0
    s_mov_b32 s52, s42
    s_mov_b32 s53, s43
    s_mov_b32 s54, 3145728
    s_mov_b32 s55, 0x20000
    s_mov_b32 s44, s42
    s_mov_b32 s45, s43
    s_mov_b32 s46, 0
    s_mov_b32 s47, 0x20000
    s_mov_b32 s48, s42
    s_mov_b32 s49, s43
    s_mov_b32 s50, 0
    s_mov_b32 s51, 0x20000
    s_mov_b32 s56, s42
    s_mov_b32 s57, s43
    s_mov_b32 s58, 0
    s_mov_b32 s59, 0x20000
    s_setprio 1
    s_sub_u32 s76, s3, 4
    s_mov_b32 s71, 0
    s_cmp_lg_u32 s76, 2
    s_cbranch_scc1 L_noinit
    v_lshlrev_b32 v8, 2, v3
    v_mov_b32 v9, 0
    s_mov_b64 exec, 0xffff
    ds_write_b32 v8, v9
    s_mov_b64 exec, -1
    s_waitcnt lgkmcnt(0)
L_noinit:
    s_barrier
    v_mov_b32 v40, 0
    v_mov_b32 v41, 0
    v_mov_b32 v42, 0
    v_mov_b32 v43, 0
    v_mov_b32 v44, 0
    v_mov_b32 v45, 0
    v_mov_b32 v46, 0
    v_mov_b32 v47, 0
    v_mov_b32 v48, 0
    v_mov_b32 v49, 0
    v_mov_b32 v50, 0
    v_mov_b32 v51, 0
    v_mov_b32 v52, 0
    v_mov_b32 v53, 0
    v_mov_b32 v54, 0
    v_mov_b32 v55, 0
    v_mov_b32 v56, 0
    v_mov_b32 v57, 0
    v_mov_b32 v58, 0
    v_mov_b32 v59, 0
    v_mov_b32 v80, 0
    v_mov_b32 v81, 0
    v_mov_b32 v82, 0
    v_mov_b32 v83, 0
    v_mov_b32 v84, 0
    v_mov_b32 v85, 0
    v_mov_b32 v86, 0
    v_mov_b32 v87, 0
    v_mov_b32 v88, 0
    v_mov_b32 v89, 0
    s_cmp_eq_u32 s76, 0
    s_cbranch_scc1 L_h0
    s_cmp_eq_u32 s76, 1
    s_cbranch_scc1 L_h1
    s_branch L_nounit
L_h0:
    s_mov_b32 s62, s2
    s_cmp_lt_u32 s2, 192
    s_cbranch_scc1 L_qunit
    s_cmp_ge_u32 s2, 246
    s_cbranch_scc1 L_nounit
    s_sub_u32 s67, s2, 192
    s_mul_i32 s77, s67, 0x5556
    s_lshr_b32 s77, s77, 16
    s_mul_i32 s78, s77, 3
    s_sub_u32 s78, s67, s78
    s_branch L_munit
L_h1:
    s_cmp_lt_u32 s2, 72
    s_cbranch_scc1 L_nounit
    s_cmp_ge_u32 s2, 180
    s_cbranch_scc1 L_nounit
    s_sub_u32 s67, s2, 72
    s_mul_i32 s77, s67, 0x5556
    s_lshr_b32 s77, s77, 16
    s_mul_i32 s78, s77, 3
    s_sub_u32 s78, s67, s78
    s_add_u32 s77, s77, 18
L_munit:
    s_lshl_b32 s67, s77, 7
    s_add_u32 s44, s36, s67
    s_addc_u32 s45, s37, 0
    s_sub_u32 s46, 3981312, s67
    s_mov_b32 s47, 0x20000
    s_mov_b32 s48, s34
    s_mov_b32 s49, s35
    s_mov_b32 s50, 1152
    s_mov_b32 s51, 0x20000
    s_mul_i32 s65, s78, 384
    v_lshlrev_b32 v8, 3, v3
    buffer_load_dwordx2 v[40:41], v8, s[48:51], s65 offen
    s_mov_b32 s79, 6912
    s_mul_i32 s65, s78, 192
    v_lshrrev_b32 v1, 3, v3
    v_add_u32 v1, s65, v1
    v_mul_lo_u32 v1, v1, s79
    v_and_b32 v2, 7, v3
    v_lshl_add_u32 v1, v2, 4, v1
    s_lshl_b32 s66, s79, 3
    s_mov_b32 s65, 0
    buffer_load_dwordx4 a[0:3], v1, s[44:47], s65 offen nt
    s_add_u32 s65, s65, s66
    buffer_load_dwordx4 a[4:7], v1, s[44:47], s65 offen nt
    s_add_u32 s65, s65, s66
    buffer_load_dwordx4 a[8:11], v1, s[44:47], s65 offen nt
    s_add_u32 s65, s65, s66
    buffer_load_dwordx4 a[12:15], v1, s[44:47], s65 offen nt
    s_add_u32 s65, s65, s66
    buffer_load_dwordx4 a[16:19], v1, s[44:47], s65 offen nt
    s_add_u32 s65, s65, s66
    buffer_load_dwordx4 a[20:23], v1, s[44:47], s65 offen nt
    s_add_u32 s65, s65, s66
    buffer_load_dwordx4 a[24:27], v1, s[44:47], s65 offen nt
    s_add_u32 s65, s65, s66
    buffer_load_dwordx4 a[28:31], v1, s[44:47], s65 offen nt
    s_add_u32 s65, s65, s66
    buffer_load_dwordx4 a[32:35], v1, s[44:47], s65 offen nt
    s_add_u32 s65, s65, s66
    buffer_load_dwordx4 a[36:39], v1, s[44:47], s65 offen nt
    s_add_u32 s65, s65, s66
    buffer_load_dwordx4 a[40:43], v1, s[44:47], s65 offen nt
    s_add_u32 s65, s65, s66
    buffer_load_dwordx4 a[44:47], v1, s[44:47], s65 offen nt
    s_add_u32 s65, s65, s66
    buffer_load_dwordx4 a[48:51], v1, s[44:47], s65 offen nt
    s_add_u32 s65, s65, s66
    buffer_load_dwordx4 a[52:55], v1, s[44:47], s65 offen nt
    s_add_u32 s65, s65, s66
    buffer_load_dwordx4 a[56:59], v1, s[44:47], s65 offen nt
    s_add_u32 s65, s65, s66
    buffer_load_dwordx4 a[60:63], v1, s[44:47], s65 offen nt
    s_add_u32 s65, s65, s66
    buffer_load_dwordx4 a[64:67], v1, s[44:47], s65 offen nt
    s_add_u32 s65, s65, s66
    buffer_load_dwordx4 a[68:71], v1, s[44:47], s65 offen nt
    s_add_u32 s65, s65, s66
    buffer_load_dwordx4 a[72:75], v1, s[44:47], s65 offen nt
    s_add_u32 s65, s65, s66
    buffer_load_dwordx4 a[76:79], v1, s[44:47], s65 offen nt
    s_add_u32 s65, s65, s66
    buffer_load_dwordx4 a[80:83], v1, s[44:47], s65 offen nt
    s_add_u32 s65, s65, s66
    buffer_load_dwordx4 a[84:87], v1, s[44:47], s65 offen nt
    s_add_u32 s65, s65, s66
    buffer_load_dwordx4 a[88:91], v1, s[44:47], s65 offen nt
    s_add_u32 s65, s65, s66
    buffer_load_dwordx4 a[92:95], v1, s[44:47], s65 offen nt
    s_waitcnt lgkmcnt(0)
    s_add_u32 s64, s64, 1
    s_and_b32 s68, s64, 0xff
    v_mov_b32 v60, s68
    s_mul_i32 s79, s77, 3
    s_add_u32 s79, s79, s78
    s_lshl_b32 s79, s79, 8
    s_add_u32 s79, s79, 524288
    v_and_b32 v8, 1, v3
    v_mul_u32_u24 v8, 384, v8
    v_lshrrev_b32 v2, 1, v3
    v_lshl_add_u32 v2, v2, 2, v8
    s_mul_i32 s65, s76, 768
    s_add_u32 s65, s65, 512
    v_add_u32 v2, s65, v2
    s_waitcnt vmcnt(24)
    v_lshlrev_b32 v44, 16, v40
    v_and_b32 v45, s80, v40
    v_lshlrev_b32 v46, 16, v41
    v_and_b32 v47, s80, v41
    v_mul_f32 v48, 0xbfb8aa3b, v44
    v_exp_f32 v48, v48
    s_nop 0
    v_add_f32 v48, 1.0, v48
    v_rcp_f32 v48, v48
    v_mul_f32 v49, 0xbfb8aa3b, v45
    v_exp_f32 v49, v49
    s_nop 0
    v_add_f32 v49, 1.0, v49
    v_rcp_f32 v49, v49
    v_mul_f32 v50, 0xbfb8aa3b, v46
    v_exp_f32 v50, v50
    s_nop 0
    v_add_f32 v50, 1.0, v50
    v_rcp_f32 v50, v50
    v_mul_f32 v51, 0xbfb8aa3b, v47
    v_exp_f32 v51, v51
    s_nop 0
    v_add_f32 v51, 1.0, v51
    v_rcp_f32 v51, v51
    v_mul_f32 v44, v44, v48
    v_mul_f32 v45, v45, v49
    v_mul_f32 v46, v46, v50
    v_mul_f32 v47, v47, v51
    v_cvt_pk_bf16_f32 v44, v44, v44
    v_cvt_pk_bf16_f32 v45, v45, v45
    v_cvt_pk_bf16_f32 v46, v46, v46
    v_cvt_pk_bf16_f32 v47, v47, v47
    s_mov_b32 exec_lo, 0xffffffff
    s_mov_b32 exec_hi, 0x0000ffff
    ds_write_b32 v2, v44 offset:0
    ds_write_b32 v2, v45 offset:96
    ds_write_b32 v2, v46 offset:192
    ds_write_b32 v2, v47 offset:288
    s_mov_b64 exec, -1
    s_branch L_unit_gemv
L_qunit:
    s_mul_i32 s77, s62, 0x5556
    s_lshr_b32 s77, s77, 16
    s_mul_i32 s78, s77, 3
    s_sub_u32 s78, s62, s78
    s_lshl_b32 s67, s77, 7
    s_add_u32 s44, s22, s67
    s_addc_u32 s45, s23, 0
    s_sub_u32 s46, 4718592, s67
    s_mov_b32 s47, 0x20000
    s_mov_b32 s48, s16
    s_mov_b32 s49, s17
    s_mov_b32 s50, 1152
    s_mov_b32 s51, 0x20000
    v_lshrrev_b32 v8, 3, v3
    v_lshlrev_b32 v8, 5, v8
    v_and_b32 v9, 7, v3
    v_add_u32 v8, v8, v9
    v_lshlrev_b32 v8, 1, v8
    s_mul_i32 s65, s78, 384
    buffer_load_ushort v44, v8, s[48:51], s65 offen offset:0
    buffer_load_ushort v45, v8, s[48:51], s65 offen offset:16
    buffer_load_ushort v46, v8, s[48:51], s65 offen offset:32
    buffer_load_ushort v47, v8, s[48:51], s65 offen offset:48
    v_lshlrev_b32 v9, 5, v3
    buffer_load_dwordx4 v[16:19], v9, s[48:51], 0 offen
    buffer_load_dwordx4 v[20:23], v9, s[48:51], 0 offen offset:16
    s_mov_b32 s79, 8192
    s_mul_i32 s65, s78, 192
    v_lshrrev_b32 v1, 3, v3
    v_add_u32 v1, s65, v1
    v_mul_lo_u32 v1, v1, s79
    v_and_b32 v2, 7, v3
    v_lshl_add_u32 v1, v2, 4, v1
    s_lshl_b32 s66, s79, 3
    s_mov_b32 s65, 0
    buffer_load_dwordx4 a[0:3], v1, s[44:47], s65 offen nt
    s_add_u32 s65, s65, s66
    buffer_load_dwordx4 a[4:7], v1, s[44:47], s65 offen nt
    s_add_u32 s65, s65, s66
    buffer_load_dwordx4 a[8:11], v1, s[44:47], s65 offen nt
    s_add_u32 s65, s65, s66
    buffer_load_dwordx4 a[12:15], v1, s[44:47], s65 offen nt
    s_add_u32 s65, s65, s66
    buffer_load_dwordx4 a[16:19], v1, s[44:47], s65 offen nt
    s_add_u32 s65, s65, s66
    buffer_load_dwordx4 a[20:23], v1, s[44:47], s65 offen nt
    s_add_u32 s65, s65, s66
    buffer_load_dwordx4 a[24:27], v1, s[44:47], s65 offen nt
    s_add_u32 s65, s65, s66
    buffer_load_dwordx4 a[28:31], v1, s[44:47], s65 offen nt
    s_add_u32 s65, s65, s66
    buffer_load_dwordx4 a[32:35], v1, s[44:47], s65 offen nt
    s_add_u32 s65, s65, s66
    buffer_load_dwordx4 a[36:39], v1, s[44:47], s65 offen nt
    s_add_u32 s65, s65, s66
    buffer_load_dwordx4 a[40:43], v1, s[44:47], s65 offen nt
    s_add_u32 s65, s65, s66
    buffer_load_dwordx4 a[44:47], v1, s[44:47], s65 offen nt
    s_add_u32 s65, s65, s66
    buffer_load_dwordx4 a[48:51], v1, s[44:47], s65 offen nt
    s_add_u32 s65, s65, s66
    buffer_load_dwordx4 a[52:55], v1, s[44:47], s65 offen nt
    s_add_u32 s65, s65, s66
    buffer_load_dwordx4 a[56:59], v1, s[44:47], s65 offen nt
    s_add_u32 s65, s65, s66
    buffer_load_dwordx4 a[60:63], v1, s[44:47], s65 offen nt
    s_add_u32 s65, s65, s66
    buffer_load_dwordx4 a[64:67], v1, s[44:47], s65 offen nt
    s_add_u32 s65, s65, s66
    buffer_load_dwordx4 a[68:71], v1, s[44:47], s65 offen nt
    s_add_u32 s65, s65, s66
    buffer_load_dwordx4 a[72:75], v1, s[44:47], s65 offen nt
    s_add_u32 s65, s65, s66
    buffer_load_dwordx4 a[76:79], v1, s[44:47], s65 offen nt
    s_add_u32 s65, s65, s66
    buffer_load_dwordx4 a[80:83], v1, s[44:47], s65 offen nt
    s_add_u32 s65, s65, s66
    buffer_load_dwordx4 a[84:87], v1, s[44:47], s65 offen nt
    s_add_u32 s65, s65, s66
    buffer_load_dwordx4 a[88:91], v1, s[44:47], s65 offen nt
    s_add_u32 s65, s65, s66
    buffer_load_dwordx4 a[92:95], v1, s[44:47], s65 offen nt
    s_waitcnt lgkmcnt(0)
    s_add_u32 s64, s64, 1
    s_and_b32 s68, s64, 0xff
    v_mov_b32 v60, s68
    s_mul_i32 s79, s77, 3
    s_add_u32 s79, s79, s78
    s_lshl_b32 s79, s79, 8
    s_add_u32 s79, s79, 589824
    s_mul_i32 s65, s78, 6
    v_lshrrev_b32 v8, 3, v3
    v_add_u32 v8, s65, v8
    v_lshrrev_b32 v9, 1, v8
    v_mul_u32_u24 v9, 768, v9
    v_and_b32 v8, 1, v8
    v_lshl_add_u32 v9, v8, 7, v9
    v_and_b32 v8, 7, v3
    v_lshl_add_u32 v50, v8, 4, v9
    v_mul_u32_u24 v51, 96, v8
    v_lshrrev_b32 v9, 3, v3
    v_lshl_add_u32 v51, v9, 4, v51
    s_mul_i32 s65, s76, 768
    s_add_u32 s65, s65, 512
    v_add_u32 v51, s65, v51
    s_waitcnt vmcnt(24)
    v_lshlrev_b32 v44, 16, v44
    v_lshlrev_b32 v45, 16, v45
    v_lshlrev_b32 v46, 16, v46
    v_lshlrev_b32 v47, 16, v47
    v_lshlrev_b32 v24, 16, v16
    v_and_b32 v25, s80, v16
    v_lshlrev_b32 v26, 16, v17
    v_and_b32 v27, s80, v17
    v_lshlrev_b32 v28, 16, v18
    v_and_b32 v29, s80, v18
    v_lshlrev_b32 v30, 16, v19
    v_and_b32 v31, s80, v19
    v_lshlrev_b32 v32, 16, v20
    v_and_b32 v33, s80, v20
    v_lshlrev_b32 v34, 16, v21
    v_and_b32 v35, s80, v21
    v_lshlrev_b32 v36, 16, v22
    v_and_b32 v37, s80, v22
    v_lshlrev_b32 v38, 16, v23
    v_and_b32 v39, s80, v23
    v_add_f32 v48, v24, v25
    v_add_f32 v48, v48, v26
    v_add_f32 v48, v48, v27
    v_add_f32 v48, v48, v28
    v_add_f32 v48, v48, v29
    v_add_f32 v48, v48, v30
    v_add_f32 v48, v48, v31
    v_add_f32 v48, v48, v32
    v_add_f32 v48, v48, v33
    v_add_f32 v48, v48, v34
    v_add_f32 v48, v48, v35
    v_add_f32 v48, v48, v36
    v_add_f32 v48, v48, v37
    v_add_f32 v48, v48, v38
    v_add_f32 v48, v48, v39
    s_nop 1
    v_add_f32_dpp v48, v48, v48 quad_perm:[1,0,3,2] row_mask:0xf bank_mask:0xf
    s_nop 1
    v_add_f32_dpp v48, v48, v48 quad_perm:[2,3,0,1] row_mask:0xf bank_mask:0xf
    s_nop 1
    v_add_f32_dpp v48, v48, v48 row_ror:4 row_mask:0xf bank_mask:0xf
    s_nop 1
    v_add_f32_dpp v48, v48, v48 row_ror:8 row_mask:0xf bank_mask:0xf
    v_mov_b32 v49, v48
    s_nop 1
    v_permlane16_swap_b32 v48, v49
    v_add_f32 v48, v48, v49
    v_mov_b32 v49, v48
    s_nop 1
    v_permlane32_swap_b32 v48, v49
    v_add_f32 v48, v48, v49
    v_mul_f32 v48, 0x3ae38e39, v48
    v_sub_f32 v24, v24, v48
    v_sub_f32 v25, v25, v48
    v_sub_f32 v26, v26, v48
    v_sub_f32 v27, v27, v48
    v_sub_f32 v28, v28, v48
    v_sub_f32 v29, v29, v48
    v_sub_f32 v30, v30, v48
    v_sub_f32 v31, v31, v48
    v_sub_f32 v32, v32, v48
    v_sub_f32 v33, v33, v48
    v_sub_f32 v34, v34, v48
    v_sub_f32 v35, v35, v48
    v_sub_f32 v36, v36, v48
    v_sub_f32 v37, v37, v48
    v_sub_f32 v38, v38, v48
    v_sub_f32 v39, v39, v48
    v_mul_f32 v49, v24, v24
    v_fmac_f32 v49, v25, v25
    v_fmac_f32 v49, v26, v26
    v_fmac_f32 v49, v27, v27
    v_fmac_f32 v49, v28, v28
    v_fmac_f32 v49, v29, v29
    v_fmac_f32 v49, v30, v30
    v_fmac_f32 v49, v31, v31
    v_fmac_f32 v49, v32, v32
    v_fmac_f32 v49, v33, v33
    v_fmac_f32 v49, v34, v34
    v_fmac_f32 v49, v35, v35
    v_fmac_f32 v49, v36, v36
    v_fmac_f32 v49, v37, v37
    v_fmac_f32 v49, v38, v38
    v_fmac_f32 v49, v39, v39
    v_cmp_gt_u32 vcc, 36, v3
    s_nop 1
    v_cndmask_b32 v49, 0, v49, vcc
    s_nop 1
    v_add_f32_dpp v49, v49, v49 quad_perm:[1,0,3,2] row_mask:0xf bank_mask:0xf
    s_nop 1
    v_add_f32_dpp v49, v49, v49 quad_perm:[2,3,0,1] row_mask:0xf bank_mask:0xf
    s_nop 1
    v_add_f32_dpp v49, v49, v49 row_ror:4 row_mask:0xf bank_mask:0xf
    s_nop 1
    v_add_f32_dpp v49, v49, v49 row_ror:8 row_mask:0xf bank_mask:0xf
    v_mov_b32 v52, v49
    s_nop 1
    v_permlane16_swap_b32 v49, v52
    v_add_f32 v49, v49, v52
    v_mov_b32 v52, v49
    s_nop 1
    v_permlane32_swap_b32 v49, v52
    v_add_f32 v49, v49, v52
    v_mul_f32 v49, 0x3ae38e39, v49
    v_cvt_pk_bf16_f32 v52, v48, v49
    v_lshlrev_b32 v48, 16, v52
    v_and_b32 v49, s80, v52
    v_add_f32 v49, 0x3727c5ac, v49
    v_cvt_pk_bf16_f32 v52, v49, v49
    v_lshlrev_b32 v49, 16, v52
    v_sqrt_f32 v49, v49
    s_nop 0
    v_cvt_pk_bf16_f32 v52, v49, v49
    v_lshlrev_b32 v49, 16, v52
    v_rcp_f32 v49, v49
    v_sub_f32 v44, v44, v48
    v_sub_f32 v45, v45, v48
    v_sub_f32 v46, v46, v48
    v_sub_f32 v47, v47, v48
    v_cvt_pk_bf16_f32 v52, v44, v45
    v_lshlrev_b32 v44, 16, v52
    v_and_b32 v45, s80, v52
    v_cvt_pk_bf16_f32 v52, v46, v47
    v_lshlrev_b32 v46, 16, v52
    v_and_b32 v47, s80, v52
    v_mul_f32 v44, v44, v49
    v_mul_f32 v45, v45, v49
    v_mul_f32 v46, v46, v49
    v_mul_f32 v47, v47, v49
    v_cvt_pk_bf16_f32 v52, v44, v45
    v_lshlrev_b32 v44, 16, v52
    v_and_b32 v45, s80, v52
    v_cvt_pk_bf16_f32 v52, v46, v47
    v_lshlrev_b32 v46, 16, v52
    v_and_b32 v47, s80, v52
    s_mov_b32 exec_lo, 0xffffffff
    s_mov_b32 exec_hi, 0x0000ffff
    s_sleep 60
    s_mov_b32 s68, 524288
    buffer_load_dwordx4 v[8:11], v50, s[52:55], s68 offen offset:0 sc1
    s_mov_b32 s68, 524288
    buffer_load_dwordx4 v[12:15], v50, s[52:55], s68 offen offset:256 sc1
    s_mov_b32 s68, 524288
    buffer_load_dwordx4 v[16:19], v50, s[52:55], s68 offen offset:512 sc1
    s_mov_b32 s68, 531200
    buffer_load_dwordx4 v[20:23], v50, s[52:55], s68 offen offset:0 sc1
    s_mov_b32 s68, 531200
    buffer_load_dwordx4 v[24:27], v50, s[52:55], s68 offen offset:256 sc1
    s_mov_b32 s68, 531200
    buffer_load_dwordx4 v[28:31], v50, s[52:55], s68 offen offset:512 sc1
    s_mov_b32 s70, 0
    s_waitcnt vmcnt(5)
    v_cmp_ne_u32_sdwa vcc, v60, v8 src0_sel:BYTE_0 src1_sel:BYTE_0
    s_cbranch_vccz Lk_8
    s_bitset1_b32 s70, 0
Lk_8:
    s_waitcnt vmcnt(4)
    v_cmp_ne_u32_sdwa vcc, v60, v12 src0_sel:BYTE_0 src1_sel:BYTE_0
    s_cbranch_vccz Lk_9
    s_bitset1_b32 s70, 1
Lk_9:
    s_waitcnt vmcnt(3)
    v_cmp_ne_u32_sdwa vcc, v60, v16 src0_sel:BYTE_0 src1_sel:BYTE_0
    s_cbranch_vccz Lk_10
    s_bitset1_b32 s70, 2
Lk_10:
    s_waitcnt vmcnt(2)
    v_cmp_ne_u32_sdwa vcc, v60, v20 src0_sel:BYTE_0 src1_sel:BYTE_0
    s_cbranch_vccz Lk_11
    s_bitset1_b32 s70, 3
Lk_11:
    s_waitcnt vmcnt(1)
    v_cmp_ne_u32_sdwa vcc, v60, v24 src0_sel:BYTE_0 src1_sel:BYTE_0
    s_cbranch_vccz Lk_12
    s_bitset1_b32 s70, 4
Lk_12:
    s_waitcnt vmcnt(0)
    v_cmp_ne_u32_sdwa vcc, v60, v28 src0_sel:BYTE_0 src1_sel:BYTE_0
    s_cbranch_vccz Lk_13
    s_bitset1_b32 s70, 5
Lk_13:
    s_cmp_eq_u32 s70, 0
    s_cbranch_scc1 Lpolled_7
    s_mov_b32 s69, 0
Lpoll_6:
    s_sleep 16
    s_bitcmp1_b32 s70, 0
    s_cbranch_scc0 Ls_14
    s_mov_b32 s68, 524288
    buffer_load_dwordx4 v[8:11], v50, s[52:55], s68 offen offset:0 sc1
Ls_14:
    s_bitcmp1_b32 s70, 1
    s_cbranch_scc0 Ls_15
    s_mov_b32 s68, 524288
    buffer_load_dwordx4 v[12:15], v50, s[52:55], s68 offen offset:256 sc1
Ls_15:
    s_bitcmp1_b32 s70, 2
    s_cbranch_scc0 Ls_16
    s_mov_b32 s68, 524288
    buffer_load_dwordx4 v[16:19], v50, s[52:55], s68 offen offset:512 sc1
Ls_16:
    s_bitcmp1_b32 s70, 3
    s_cbranch_scc0 Ls_17
    s_mov_b32 s68, 531200
    buffer_load_dwordx4 v[20:23], v50, s[52:55], s68 offen offset:0 sc1
Ls_17:
    s_bitcmp1_b32 s70, 4
    s_cbranch_scc0 Ls_18
    s_mov_b32 s68, 531200
    buffer_load_dwordx4 v[24:27], v50, s[52:55], s68 offen offset:256 sc1
Ls_18:
    s_bitcmp1_b32 s70, 5
    s_cbranch_scc0 Ls_19
    s_mov_b32 s68, 531200
    buffer_load_dwordx4 v[28:31], v50, s[52:55], s68 offen offset:512 sc1
Ls_19:
    s_waitcnt vmcnt(0)
    s_bitcmp1_b32 s70, 0
    s_cbranch_scc0 Lt_20
    v_cmp_ne_u32_sdwa vcc, v60, v8 src0_sel:BYTE_0 src1_sel:BYTE_0
    s_cbranch_vccnz Lt_20
    s_bitset0_b32 s70, 0
Lt_20:
    s_bitcmp1_b32 s70, 1
    s_cbranch_scc0 Lt_21
    v_cmp_ne_u32_sdwa vcc, v60, v12 src0_sel:BYTE_0 src1_sel:BYTE_0
    s_cbranch_vccnz Lt_21
    s_bitset0_b32 s70, 1
Lt_21:
    s_bitcmp1_b32 s70, 2
    s_cbranch_scc0 Lt_22
    v_cmp_ne_u32_sdwa vcc, v60, v16 src0_sel:BYTE_0 src1_sel:BYTE_0
    s_cbranch_vccnz Lt_22
    s_bitset0_b32 s70, 2
Lt_22:
    s_bitcmp1_b32 s70, 3
    s_cbranch_scc0 Lt_23
    v_cmp_ne_u32_sdwa vcc, v60, v20 src0_sel:BYTE_0 src1_sel:BYTE_0
    s_cbranch_vccnz Lt_23
    s_bitset0_b32 s70, 3
Lt_23:
    s_bitcmp1_b32 s70, 4
    s_cbranch_scc0 Lt_24
    v_cmp_ne_u32_sdwa vcc, v60, v24 src0_sel:BYTE_0 src1_sel:BYTE_0
    s_cbranch_vccnz Lt_24
    s_bitset0_b32 s70, 4
Lt_24:
    s_bitcmp1_b32 s70, 5
    s_cbranch_scc0 Lt_25
    v_cmp_ne_u32_sdwa vcc, v60, v28 src0_sel:BYTE_0 src1_sel:BYTE_0
    s_cbranch_vccnz Lt_25
    s_bitset0_b32 s70, 5
Lt_25:
    s_cmp_eq_u32 s70, 0
    s_cbranch_scc1 Lpolled_7
    s_add_u32 s69, s69, 1
    s_cmp_lt_u32 s69, 200000
    s_cbranch_scc1 Lpoll_6
Lpolled_7:
    v_pk_add_f32 v[8:9], v[8:9], v[12:13]
    v_pk_add_f32 v[10:11], v[10:11], v[14:15]
    v_pk_add_f32 v[8:9], v[8:9], v[16:17]
    v_pk_add_f32 v[10:11], v[10:11], v[18:19]
    v_pk_add_f32 v[20:21], v[20:21], v[24:25]
    v_pk_add_f32 v[22:23], v[22:23], v[26:27]
    v_pk_add_f32 v[20:21], v[20:21], v[28:29]
    v_pk_add_f32 v[22:23], v[22:23], v[30:31]
    v_cvt_pk_bf16_f32 v52, v8, v9
    v_lshlrev_b32 v8, 16, v52
    v_and_b32 v9, s80, v52
    v_cvt_pk_bf16_f32 v52, v10, v11
    v_lshlrev_b32 v10, 16, v52
    v_and_b32 v11, s80, v52
    v_cvt_pk_bf16_f32 v53, v20, v21
    v_lshlrev_b32 v20, 16, v53
    v_and_b32 v21, s80, v53
    v_cvt_pk_bf16_f32 v53, v22, v23
    v_lshlrev_b32 v22, 16, v53
    v_and_b32 v23, s80, v53
    v_add_f32 v20, 1.0, v20
    v_add_f32 v21, 1.0, v21
    v_add_f32 v22, 1.0, v22
    v_add_f32 v23, 1.0, v23
    v_cvt_pk_bf16_f32 v52, v20, v21
    v_lshlrev_b32 v20, 16, v52
    v_and_b32 v21, s80, v52
    v_cvt_pk_bf16_f32 v52, v22, v23
    v_lshlrev_b32 v22, 16, v52
    v_and_b32 v23, s80, v52
    v_mul_f32 v44, v44, v20
    v_mul_f32 v45, v45, v21
    v_mul_f32 v46, v46, v22
    v_mul_f32 v47, v47, v23
    v_cvt_pk_bf16_f32 v52, v44, v45
    v_lshlrev_b32 v44, 16, v52
    v_and_b32 v45, s80, v52
    v_cvt_pk_bf16_f32 v52, v46, v47
    v_lshlrev_b32 v46, 16, v52
    v_and_b32 v47, s80, v52
    v_add_f32 v44, v44, v8
    v_add_f32 v45, v45, v9
    v_add_f32 v46, v46, v10
    v_add_f32 v47, v47, v11
    v_cvt_pk_bf16_f32 v44, v44, v44
    v_cvt_pk_bf16_f32 v45, v45, v45
    v_cvt_pk_bf16_f32 v46, v46, v46
    v_cvt_pk_bf16_f32 v47, v47, v47
    ds_write_b128 v51, v[44:47]
    s_mov_b64 exec, -1
L_unit_gemv:
    v_lshrrev_b32 v2, 3, v3
    v_mul_u32_u24 v2, 96, v2
    s_mul_i32 s65, s76, 768
    s_add_u32 s65, s65, 512
    v_add_u32 v2, s65, v2
    ds_read_b128 v[16:19], v2 offset:0
    ds_read_b128 v[20:23], v2 offset:16
    ds_read_b128 v[24:27], v2 offset:32
    ds_read_b128 v[28:31], v2 offset:48
    ds_read_b128 v[32:35], v2 offset:64
    ds_read_b128 v[36:39], v2 offset:80
    s_waitcnt lgkmcnt(0)
    v_and_b32 v8, v16, v4
    v_and_b32 v9, v16, v5
    v_and_b32 v10, v16, v6
    v_and_b32 v11, v16, v7
    v_and_b32 v12, v17, v4
    v_and_b32 v13, v17, v5
    v_and_b32 v14, v17, v6
    v_and_b32 v15, v17, v7
    s_waitcnt vmcnt(20)
    v_mfma_f32_16x16x32_bf16 v[40:43], a[0:3], v[8:11], 0
    v_and_b32 v8, v18, v4
    v_and_b32 v9, v18, v5
    v_and_b32 v10, v18, v6
    v_and_b32 v11, v18, v7
    v_mfma_f32_16x16x32_bf16 v[40:43], a[4:7], v[12:15], v[40:43]
    v_and_b32 v12, v19, v4
    v_and_b32 v13, v19, v5
    v_and_b32 v14, v19, v6
    v_and_b32 v15, v19, v7
    v_mfma_f32_16x16x32_bf16 v[40:43], a[8:11], v[8:11], v[40:43]
    v_and_b32 v8, v20, v4
    v_and_b32 v9, v20, v5
    v_and_b32 v10, v20, v6
    v_and_b32 v11, v20, v7
    v_mfma_f32_16x16x32_bf16 v[40:43], a[12:15], v[12:15], v[40:43]
    v_and_b32 v12, v21, v4
    v_and_b32 v13, v21, v5
    v_and_b32 v14, v21, v6
    v_and_b32 v15, v21, v7
    s_waitcnt vmcnt(16)
    v_mfma_f32_16x16x32_bf16 v[40:43], a[16:19], v[8:11], v[40:43]
    v_and_b32 v8, v22, v4
    v_and_b32 v9, v22, v5
    v_and_b32 v10, v22, v6
    v_and_b32 v11, v22, v7
    v_mfma_f32_16x16x32_bf16 v[40:43], a[20:23], v[12:15], v[40:43]
    v_and_b32 v12, v23, v4
    v_and_b32 v13, v23, v5
    v_and_b32 v14, v23, v6
    v_and_b32 v15, v23, v7
    v_mfma_f32_16x16x32_bf16 v[40:43], a[24:27], v[8:11], v[40:43]
    v_and_b32 v8, v24, v4
    v_and_b32 v9, v24, v5
    v_and_b32 v10, v24, v6
    v_and_b32 v11, v24, v7
    v_mfma_f32_16x16x32_bf16 v[40:43], a[28:31], v[12:15], v[40:43]
    v_and_b32 v12, v25, v4
    v_and_b32 v13, v25, v5
    v_and_b32 v14, v25, v6
    v_and_b32 v15, v25, v7
    s_waitcnt vmcnt(12)
    v_mfma_f32_16x16x32_bf16 v[40:43], a[32:35], v[8:11], v[40:43]
    v_and_b32 v8, v26, v4
    v_and_b32 v9, v26, v5
    v_and_b32 v10, v26, v6
    v_and_b32 v11, v26, v7
    v_mfma_f32_16x16x32_bf16 v[40:43], a[36:39], v[12:15], v[40:43]
    v_and_b32 v12, v27, v4
    v_and_b32 v13, v27, v5
    v_and_b32 v14, v27, v6
    v_and_b32 v15, v27, v7
    v_mfma_f32_16x16x32_bf16 v[40:43], a[40:43], v[8:11], v[40:43]
    v_and_b32 v8, v28, v4
    v_and_b32 v9, v28, v5
    v_and_b32 v10, v28, v6
    v_and_b32 v11, v28, v7
    v_mfma_f32_16x16x32_bf16 v[40:43], a[44:47], v[12:15], v[40:43]
    v_and_b32 v12, v29, v4
    v_and_b32 v13, v29, v5
    v_and_b32 v14, v29, v6
    v_and_b32 v15, v29, v7
    s_waitcnt vmcnt(8)
    v_mfma_f32_16x16x32_bf16 v[40:43], a[48:51], v[8:11], v[40:43]
    v_and_b32 v8, v30, v4
    v_and_b32 v9, v30, v5
    v_and_b32 v10, v30, v6
    v_and_b32 v11, v30, v7
    v_mfma_f32_16x16x32_bf16 v[40:43], a[52:55], v[12:15], v[40:43]
    v_and_b32 v12, v31, v4
    v_and_b32 v13, v31, v5
    v_and_b32 v14, v31, v6
    v_and_b32 v15, v31, v7
    v_mfma_f32_16x16x32_bf16 v[40:43], a[56:59], v[8:11], v[40:43]
    v_and_b32 v8, v32, v4
    v_and_b32 v9, v32, v5
    v_and_b32 v10, v32, v6
    v_and_b32 v11, v32, v7
    v_mfma_f32_16x16x32_bf16 v[40:43], a[60:63], v[12:15], v[40:43]
    v_and_b32 v12, v33, v4
    v_and_b32 v13, v33, v5
    v_and_b32 v14, v33, v6
    v_and_b32 v15, v33, v7
    s_waitcnt vmcnt(4)
    v_mfma_f32_16x16x32_bf16 v[40:43], a[64:67], v[8:11], v[40:43]
    v_and_b32 v8, v34, v4
    v_and_b32 v9, v34, v5
    v_and_b32 v10, v34, v6
    v_and_b32 v11, v34, v7
    v_mfma_f32_16x16x32_bf16 v[40:43], a[68:71], v[12:15], v[40:43]
    v_and_b32 v12, v35, v4
    v_and_b32 v13, v35, v5
    v_and_b32 v14, v35, v6
    v_and_b32 v15, v35, v7
    v_mfma_f32_16x16x32_bf16 v[40:43], a[72:75], v[8:11], v[40:43]
    v_and_b32 v8, v36, v4
    v_and_b32 v9, v36, v5
    v_and_b32 v10, v36, v6
    v_and_b32 v11, v36, v7
    v_mfma_f32_16x16x32_bf16 v[40:43], a[76:79], v[12:15], v[40:43]
    v_and_b32 v12, v37, v4
    v_and_b32 v13, v37, v5
    v_and_b32 v14, v37, v6
    v_and_b32 v15, v37, v7
    s_waitcnt vmcnt(0)
    v_mfma_f32_16x16x32_bf16 v[40:43], a[80:83], v[8:11], v[40:43]
    v_and_b32 v8, v38, v4
    v_and_b32 v9, v38, v5
    v_and_b32 v10, v38, v6
    v_and_b32 v11, v38, v7
    v_mfma_f32_16x16x32_bf16 v[40:43], a[84:87], v[12:15], v[40:43]
    v_and_b32 v12, v39, v4
    v_and_b32 v13, v39, v5
    v_and_b32 v14, v39, v6
    v_and_b32 v15, v39, v7
    v_mfma_f32_16x16x32_bf16 v[40:43], a[88:91], v[8:11], v[40:43]
    s_nop 0
    v_mfma_f32_16x16x32_bf16 v[40:43], a[92:95], v[12:15], v[40:43]
    v_lshrrev_b32 v2, 4, v3
    v_lshlrev_b32 v2, 7, v2
    v_and_b32 v8, 7, v3
    v_lshl_add_u32 v2, v8, 4, v2
    s_nop 3
    v_mov_b32 v44, v40
    v_mov_b32 v45, v41
    v_mov_b32 v46, v42
    v_mov_b32 v47, v43
    v_permlane32_swap_b32 v40, v44
    v_permlane32_swap_b32 v41, v45
    v_permlane32_swap_b32 v42, v46
    v_permlane32_swap_b32 v43, v47
    v_add_f32_dpp v40, v44, v40 row_ror:8 row_mask:0xf bank_mask:0xf
    v_add_f32_dpp v41, v45, v41 row_ror:8 row_mask:0xf bank_mask:0xf
    v_add_f32_dpp v42, v46, v42 row_ror:8 row_mask:0xf bank_mask:0xf
    v_add_f32_dpp v43, v47, v43 row_ror:8 row_mask:0xf bank_mask:0xf
    v_bfi_b32 v40, s81, v60, v40
    v_bfi_b32 v41, s81, v60, v41
    v_bfi_b32 v42, s81, v60, v42
    v_bfi_b32 v43, s81, v60, v43
    s_mov_b64 exec, 0xff00ff
    buffer_store_dwordx4 v[40:43], v2, s[52:55], s79 offen sc1
    s_mov_b64 exec, -1
    s_branch L_pre_done
L_nounit:
    s_waitcnt lgkmcnt(0)
    s_add_u32 s64, s64, 1
    s_and_b32 s68, s64, 0xff
    v_mov_b32 v60, s68
L_pre_done:
    s_cmp_lg_u32 s76, 3
    s_cbranch_scc1 L_noq
    s_lshr_b32 s65, s100, 3
    s_mul_i32 s65, s65, 1536
    s_add_u32 s77, s65, 589824
    v_lshrrev_b32 v8, 4, v3
    v_mul_u32_u24 v2, 768, v8
    v_and_b32 v9, 15, v3
    v_lshl_add_u32 v2, v9, 4, v2
    v_lshlrev_b32 v8, 6, v8
    v_bfe_u32 v9, v3, 3, 1
    v_lshl_add_u32 v8, v9, 5, v8
    v_and_b32 v9, 7, v3
    v_add_u32 v8, v8, v9
    v_lshlrev_b32 v24, 1, v8
    s_sleep 127
    s_mov_b32 exec_lo, 0xffffffff
    s_mov_b32 exec_hi, 0x00000000
    s_sleep 113
    buffer_load_dwordx4 v[8:11], v2, s[52:55], s77 offen offset:0 sc1
    buffer_load_dwordx4 v[12:15], v2, s[52:55], s77 offen offset:256 sc1
    buffer_load_dwordx4 v[16:19], v2, s[52:55], s77 offen offset:512 sc1
    s_mov_b32 s70, 0
    s_waitcnt vmcnt(2)
    v_cmp_ne_u32_sdwa vcc, v60, v8 src0_sel:BYTE_0 src1_sel:BYTE_0
    s_cbranch_vccz Lk_28
    s_bitset1_b32 s70, 0
Lk_28:
    s_waitcnt vmcnt(1)
    v_cmp_ne_u32_sdwa vcc, v60, v12 src0_sel:BYTE_0 src1_sel:BYTE_0
    s_cbranch_vccz Lk_29
    s_bitset1_b32 s70, 1
Lk_29:
    s_waitcnt vmcnt(0)
    v_cmp_ne_u32_sdwa vcc, v60, v16 src0_sel:BYTE_0 src1_sel:BYTE_0
    s_cbranch_vccz Lk_30
    s_bitset1_b32 s70, 2
Lk_30:
    s_cmp_eq_u32 s70, 0
    s_cbranch_scc1 Lpolled_27
    s_mov_b32 s69, 0
Lpoll_26:
    s_sleep 16
    s_bitcmp1_b32 s70, 0
    s_cbranch_scc0 Ls_31
    buffer_load_dwordx4 v[8:11], v2, s[52:55], s77 offen offset:0 sc1
Ls_31:
    s_bitcmp1_b32 s70, 1
    s_cbranch_scc0 Ls_32
    buffer_load_dwordx4 v[12:15], v2, s[52:55], s77 offen offset:256 sc1
Ls_32:
    s_bitcmp1_b32 s70, 2
    s_cbranch_scc0 Ls_33
    buffer_load_dwordx4 v[16:19], v2, s[52:55], s77 offen offset:512 sc1
Ls_33:
    s_waitcnt vmcnt(0)
    s_bitcmp1_b32 s70, 0
    s_cbranch_scc0 Lt_34
    v_cmp_ne_u32_sdwa vcc, v60, v8 src0_sel:BYTE_0 src1_sel:BYTE_0
    s_cbranch_vccnz Lt_34
    s_bitset0_b32 s70, 0
Lt_34:
    s_bitcmp1_b32 s70, 1
    s_cbranch_scc0 Lt_35
    v_cmp_ne_u32_sdwa vcc, v60, v12 src0_sel:BYTE_0 src1_sel:BYTE_0
    s_cbranch_vccnz Lt_35
    s_bitset0_b32 s70, 1
Lt_35:
    s_bitcmp1_b32 s70, 2
    s_cbranch_scc0 Lt_36
    v_cmp_ne_u32_sdwa vcc, v60, v16 src0_sel:BYTE_0 src1_sel:BYTE_0
    s_cbranch_vccnz Lt_36
    s_bitset0_b32 s70, 2
Lt_36:
    s_cmp_eq_u32 s70, 0
    s_cbranch_scc1 Lpolled_27
    s_add_u32 s69, s69, 1
    s_cmp_lt_u32 s69, 200000
    s_cbranch_scc1 Lpoll_26
Lpolled_27:
    v_pk_add_f32 v[8:9], v[8:9], v[12:13]
    v_pk_add_f32 v[10:11], v[10:11], v[14:15]
    v_pk_add_f32 v[8:9], v[8:9], v[16:17]
    v_pk_add_f32 v[10:11], v[10:11], v[18:19]
    v_cvt_pk_bf16_f32 v12, v8, v9
    v_cvt_pk_bf16_f32 v13, v10, v11
    ds_write_b16 v24, v12 offset:64
    ds_write_b16_d16_hi v24, v12 offset:80
    ds_write_b16 v24, v13 offset:96
    ds_write_b16_d16_hi v24, v13 offset:112
    s_waitcnt lgkmcnt(0)
    s_mov_b64 exec, 1
    v_mov_b32 v8, 0
    v_mov_b32 v9, 1
    ds_write_b32 v8, v9
    s_mov_b64 exec, -1
L_noq:
L_tail:
    s_setprio 0
    v_mov_b32 v62, 0
    s_mov_b32 s69, 0
Lspin_37:
    ds_read_b32 v61, v62
    s_waitcnt lgkmcnt(0)
    v_readfirstlane_b32 s68, v61
    s_nop 0
    s_cmp_ge_u32 s68, 1
    s_cbranch_scc1 Lspun_38
    s_sleep 8
    s_add_u32 s69, s69, 1
    s_cmp_lt_u32 s69, 800000
    s_cbranch_scc1 Lspin_37
Lspun_38:
    s_cmp_lt_u32 s2, 72
    s_cbranch_scc1 L_wo
    s_cmp_ge_u32 s2, 252
    s_cbranch_scc1 L_hexit
    s_cmp_ge_u32 s2, 216
    s_cbranch_scc1 L_dbl
    s_sub_u32 s67, s2, 72
    s_mul_i32 s6, s67, 0x5556
    s_lshr_b32 s6, s6, 16
    s_mul_i32 s7, s6, 3
    s_sub_u32 s7, s67, s7
    s_branch L_uprep
L_dbl:
    s_sub_u32 s67, s2, 216
    s_mul_i32 s6, s67, 0x5556
    s_lshr_b32 s6, s6, 16
    s_mul_i32 s7, s6, 3
    s_sub_u32 s7, s67, s7
    s_lshl_b32 s6, s6, 1
    s_add_u32 s6, s6, 48
L_uprep:
    s_lshr_b32 s65, s76, 1
    s_lshl_b32 s7, s7, 1
    s_add_u32 s7, s7, s65
    s_and_b32 s8, s76, 1
    s_mul_i32 s9, s7, 3
    v_lshrrev_b32 v8, 3, v3
    v_add_u32 v8, s9, v8
    v_lshrrev_b32 v9, 1, v8
    v_mul_u32_u24 v9, 768, v9
    v_and_b32 v2, 1, v8
    v_lshl_add_u32 v9, v2, 7, v9
    v_and_b32 v2, 7, v3
    v_lshl_add_u32 v2, v2, 4, v9
    v_lshlrev_b32 v83, 7, v8
    v_and_b32 v9, 7, v3
    v_lshl_add_u32 v83, v9, 4, v83
    v_add_u32 v83, 262144, v83
    s_mov_b32 s48, s16
    s_mov_b32 s49, s17
    s_mov_b32 s50, 1152
    s_mov_b32 s51, 0x20000
    v_lshlrev_b32 v8, 5, v8
    v_add_u32 v8, v8, v9
    v_lshlrev_b32 v8, 1, v8
    buffer_load_ushort v64, v8, s[48:51], 0 offen offset:0
    buffer_load_ushort v65, v8, s[48:51], 0 offen offset:16
    buffer_load_ushort v66, v8, s[48:51], 0 offen offset:32
    buffer_load_ushort v67, v8, s[48:51], 0 offen offset:48
    buffer_load_ushort v86, off, s[48:51], 0
    s_mov_b64 exec, 0xffffff
    s_mov_b32 s68, 538112
    buffer_load_dwordx4 v[8:11], v2, s[52:55], s68 offen offset:0 sc1
    s_mov_b32 s68, 538112
    buffer_load_dwordx4 v[12:15], v2, s[52:55], s68 offen offset:256 sc1
    s_mov_b32 s68, 538112
    buffer_load_dwordx4 v[16:19], v2, s[52:55], s68 offen offset:512 sc1
    s_mov_b32 s68, 551936
    buffer_load_dwordx4 v[20:23], v2, s[52:55], s68 offen offset:0 sc1
    s_mov_b32 s68, 551936
    buffer_load_dwordx4 v[24:27], v2, s[52:55], s68 offen offset:256 sc1
    s_mov_b32 s68, 551936
    buffer_load_dwordx4 v[28:31], v2, s[52:55], s68 offen offset:512 sc1
    s_mov_b32 s68, 545024
    buffer_load_dwordx4 v[32:35], v2, s[52:55], s68 offen offset:0 sc1
    s_mov_b32 s68, 545024
    buffer_load_dwordx4 v[36:39], v2, s[52:55], s68 offen offset:256 sc1
    s_mov_b32 s68, 545024
    buffer_load_dwordx4 v[40:43], v2, s[52:55], s68 offen offset:512 sc1
    s_mov_b32 s70, 0
    s_waitcnt vmcnt(8)
    v_cmp_ne_u32_sdwa vcc, v60, v8 src0_sel:BYTE_0 src1_sel:BYTE_0
    s_cbranch_vccz Lk_41
    s_bitset1_b32 s70, 0
Lk_41:
    s_waitcnt vmcnt(7)
    v_cmp_ne_u32_sdwa vcc, v60, v12 src0_sel:BYTE_0 src1_sel:BYTE_0
    s_cbranch_vccz Lk_42
    s_bitset1_b32 s70, 1
Lk_42:
    s_waitcnt vmcnt(6)
    v_cmp_ne_u32_sdwa vcc, v60, v16 src0_sel:BYTE_0 src1_sel:BYTE_0
    s_cbranch_vccz Lk_43
    s_bitset1_b32 s70, 2
Lk_43:
    s_waitcnt vmcnt(5)
    v_cmp_ne_u32_sdwa vcc, v60, v20 src0_sel:BYTE_0 src1_sel:BYTE_0
    s_cbranch_vccz Lk_44
    s_bitset1_b32 s70, 3
Lk_44:
    s_waitcnt vmcnt(4)
    v_cmp_ne_u32_sdwa vcc, v60, v24 src0_sel:BYTE_0 src1_sel:BYTE_0
    s_cbranch_vccz Lk_45
    s_bitset1_b32 s70, 4
Lk_45:
    s_waitcnt vmcnt(3)
    v_cmp_ne_u32_sdwa vcc, v60, v28 src0_sel:BYTE_0 src1_sel:BYTE_0
    s_cbranch_vccz Lk_46
    s_bitset1_b32 s70, 5
Lk_46:
    s_waitcnt vmcnt(2)
    v_cmp_ne_u32_sdwa vcc, v60, v32 src0_sel:BYTE_0 src1_sel:BYTE_0
    s_cbranch_vccz Lk_47
    s_bitset1_b32 s70, 6
Lk_47:
    s_waitcnt vmcnt(1)
    v_cmp_ne_u32_sdwa vcc, v60, v36 src0_sel:BYTE_0 src1_sel:BYTE_0
    s_cbranch_vccz Lk_48
    s_bitset1_b32 s70, 7
Lk_48:
    s_waitcnt vmcnt(0)
    v_cmp_ne_u32_sdwa vcc, v60, v40 src0_sel:BYTE_0 src1_sel:BYTE_0
    s_cbranch_vccz Lk_49
    s_bitset1_b32 s70, 8
Lk_49:
    s_cmp_eq_u32 s70, 0
    s_cbranch_scc1 Lpolled_40
    s_mov_b32 s69, 0
Lpoll_39:
    s_sleep 4
    s_bitcmp1_b32 s70, 0
    s_cbranch_scc0 Ls_50
    s_mov_b32 s68, 538112
    buffer_load_dwordx4 v[8:11], v2, s[52:55], s68 offen offset:0 sc1
Ls_50:
    s_bitcmp1_b32 s70, 1
    s_cbranch_scc0 Ls_51
    s_mov_b32 s68, 538112
    buffer_load_dwordx4 v[12:15], v2, s[52:55], s68 offen offset:256 sc1
Ls_51:
    s_bitcmp1_b32 s70, 2
    s_cbranch_scc0 Ls_52
    s_mov_b32 s68, 538112
    buffer_load_dwordx4 v[16:19], v2, s[52:55], s68 offen offset:512 sc1
Ls_52:
    s_bitcmp1_b32 s70, 3
    s_cbranch_scc0 Ls_53
    s_mov_b32 s68, 551936
    buffer_load_dwordx4 v[20:23], v2, s[52:55], s68 offen offset:0 sc1
Ls_53:
    s_bitcmp1_b32 s70, 4
    s_cbranch_scc0 Ls_54
    s_mov_b32 s68, 551936
    buffer_load_dwordx4 v[24:27], v2, s[52:55], s68 offen offset:256 sc1
Ls_54:
    s_bitcmp1_b32 s70, 5
    s_cbranch_scc0 Ls_55
    s_mov_b32 s68, 551936
    buffer_load_dwordx4 v[28:31], v2, s[52:55], s68 offen offset:512 sc1
Ls_55:
    s_bitcmp1_b32 s70, 6
    s_cbranch_scc0 Ls_56
    s_mov_b32 s68, 545024
    buffer_load_dwordx4 v[32:35], v2, s[52:55], s68 offen offset:0 sc1
Ls_56:
    s_bitcmp1_b32 s70, 7
    s_cbranch_scc0 Ls_57
    s_mov_b32 s68, 545024
    buffer_load_dwordx4 v[36:39], v2, s[52:55], s68 offen offset:256 sc1
Ls_57:
    s_bitcmp1_b32 s70, 8
    s_cbranch_scc0 Ls_58
    s_mov_b32 s68, 545024
    buffer_load_dwordx4 v[40:43], v2, s[52:55], s68 offen offset:512 sc1
Ls_58:
    s_waitcnt vmcnt(0)
    s_bitcmp1_b32 s70, 0
    s_cbranch_scc0 Lt_59
    v_cmp_ne_u32_sdwa vcc, v60, v8 src0_sel:BYTE_0 src1_sel:BYTE_0
    s_cbranch_vccnz Lt_59
    s_bitset0_b32 s70, 0
Lt_59:
    s_bitcmp1_b32 s70, 1
    s_cbranch_scc0 Lt_60
    v_cmp_ne_u32_sdwa vcc, v60, v12 src0_sel:BYTE_0 src1_sel:BYTE_0
    s_cbranch_vccnz Lt_60
    s_bitset0_b32 s70, 1
Lt_60:
    s_bitcmp1_b32 s70, 2
    s_cbranch_scc0 Lt_61
    v_cmp_ne_u32_sdwa vcc, v60, v16 src0_sel:BYTE_0 src1_sel:BYTE_0
    s_cbranch_vccnz Lt_61
    s_bitset0_b32 s70, 2
Lt_61:
    s_bitcmp1_b32 s70, 3
    s_cbranch_scc0 Lt_62
    v_cmp_ne_u32_sdwa vcc, v60, v20 src0_sel:BYTE_0 src1_sel:BYTE_0
    s_cbranch_vccnz Lt_62
    s_bitset0_b32 s70, 3
Lt_62:
    s_bitcmp1_b32 s70, 4
    s_cbranch_scc0 Lt_63
    v_cmp_ne_u32_sdwa vcc, v60, v24 src0_sel:BYTE_0 src1_sel:BYTE_0
    s_cbranch_vccnz Lt_63
    s_bitset0_b32 s70, 4
Lt_63:
    s_bitcmp1_b32 s70, 5
    s_cbranch_scc0 Lt_64
    v_cmp_ne_u32_sdwa vcc, v60, v28 src0_sel:BYTE_0 src1_sel:BYTE_0
    s_cbranch_vccnz Lt_64
    s_bitset0_b32 s70, 5
Lt_64:
    s_bitcmp1_b32 s70, 6
    s_cbranch_scc0 Lt_65
    v_cmp_ne_u32_sdwa vcc, v60, v32 src0_sel:BYTE_0 src1_sel:BYTE_0
    s_cbranch_vccnz Lt_65
    s_bitset0_b32 s70, 6
Lt_65:
    s_bitcmp1_b32 s70, 7
    s_cbranch_scc0 Lt_66
    v_cmp_ne_u32_sdwa vcc, v60, v36 src0_sel:BYTE_0 src1_sel:BYTE_0
    s_cbranch_vccnz Lt_66
    s_bitset0_b32 s70, 7
Lt_66:
    s_bitcmp1_b32 s70, 8
    s_cbranch_scc0 Lt_67
    v_cmp_ne_u32_sdwa vcc, v60, v40 src0_sel:BYTE_0 src1_sel:BYTE_0
    s_cbranch_vccnz Lt_67
    s_bitset0_b32 s70, 8
Lt_67:
    s_cmp_eq_u32 s70, 0
    s_cbranch_scc1 Lpolled_40
    s_add_u32 s69, s69, 1
    s_cmp_lt_u32 s69, 200000
    s_cbranch_scc1 Lpoll_39
Lpolled_40:
    v_pk_add_f32 v[8:9], v[8:9], v[12:13]
    v_pk_add_f32 v[10:11], v[10:11], v[14:15]
    v_pk_add_f32 v[8:9], v[8:9], v[16:17]
    v_pk_add_f32 v[10:11], v[10:11], v[18:19]
    v_cvt_pk_bf16_f32 v61, v8, v9
    v_lshlrev_b32 v8, 16, v61
    v_and_b32 v9, s80, v61
    v_cvt_pk_bf16_f32 v61, v10, v11
    v_lshlrev_b32 v10, 16, v61
    v_and_b32 v11, s80, v61
    v_mov_b32 v68, v8
    v_mov_b32 v69, v9
    v_mov_b32 v70, v10
    v_mov_b32 v71, v11
    v_pk_add_f32 v[20:21], v[20:21], v[24:25]
    v_pk_add_f32 v[22:23], v[22:23], v[26:27]
    v_pk_add_f32 v[20:21], v[20:21], v[28:29]
    v_pk_add_f32 v[22:23], v[22:23], v[30:31]
    v_cvt_pk_bf16_f32 v61, v20, v21
    v_lshlrev_b32 v20, 16, v61
    v_and_b32 v21, s80, v61
    v_cvt_pk_bf16_f32 v61, v22, v23
    v_lshlrev_b32 v22, 16, v61
    v_and_b32 v23, s80, v61
    v_mov_b32 v72, v20
    v_mov_b32 v73, v21
    v_mov_b32 v74, v22
    v_mov_b32 v75, v23
    v_pk_add_f32 v[32:33], v[32:33], v[36:37]
    v_pk_add_f32 v[34:35], v[34:35], v[38:39]
    v_pk_add_f32 v[32:33], v[32:33], v[40:41]
    v_pk_add_f32 v[34:35], v[34:35], v[42:43]
    v_cvt_pk_bf16_f32 v61, v32, v33
    v_lshlrev_b32 v32, 16, v61
    v_and_b32 v33, s80, v61
    v_cvt_pk_bf16_f32 v61, v34, v35
    v_lshlrev_b32 v34, 16, v61
    v_and_b32 v35, s80, v61
    v_mov_b32 v76, v32
    v_mov_b32 v77, v33
    v_mov_b32 v78, v34
    v_mov_b32 v79, v35
    s_mov_b64 exec, -1
    v_lshlrev_b32 v64, 16, v64
    v_lshlrev_b32 v65, 16, v65
    v_lshlrev_b32 v66, 16, v66
    v_lshlrev_b32 v67, 16, v67
    v_lshlrev_b32 v86, 16, v86
    v_sub_f32 v64, v64, v86
    v_sub_f32 v65, v65, v86
    v_sub_f32 v66, v66, v86
    v_sub_f32 v67, v67, v86
    v_add_f32 v72, 1.0, v72
    v_add_f32 v73, 1.0, v73
    v_add_f32 v74, 1.0, v74
    v_add_f32 v75, 1.0, v75
    v_cvt_pk_bf16_f32 v8, v72, v73
    v_lshlrev_b32 v72, 16, v8
    v_and_b32 v73, s80, v8
    v_cvt_pk_bf16_f32 v8, v74, v75
    v_lshlrev_b32 v74, 16, v8
    v_and_b32 v75, s80, v8
    s_mul_i32 s65, s76, 768
    s_add_u32 s65, s65, 512
    v_and_b32 v8, 7, v3
    v_mul_u32_u24 v80, 48, v8
    v_lshrrev_b32 v9, 3, v3
    v_lshl_add_u32 v80, v9, 4, v80
    v_add_u32 v80, s65, v80
    v_mul_u32_u24 v81, 48, v9
    v_add_u32 v81, s65, v81
    v_lshrrev_b32 v82, 4, v3
    v_lshlrev_b32 v82, 7, v82
    v_lshl_add_u32 v82, v8, 4, v82
    s_mul_i32 s10, s8, 72
    s_add_u32 s10, s10, s6
    s_mul_i32 s10, s10, 6
    s_add_u32 s10, s10, s7
    s_lshl_b32 s10, s10, 8
    s_cmp_eq_u32 s8, 0
    s_cselect_b32 s12, s28, s30
    s_cselect_b32 s13, s29, s31
    s_lshl_b32 s67, s6, 7
    s_add_u32 s56, s12, s67
    s_addc_u32 s57, s13, 0
    s_sub_u32 s58, 5308416, s67
    s_mov_b32 s59, 0x20000
    s_mul_i32 s11, s7, 96
    v_lshrrev_b32 v56, 3, v3
    v_add_u32 v56, s11, v56
    v_mul_u32_u24 v56, 9216, v56
    v_and_b32 v8, 7, v3
    v_lshl_add_u32 v56, v8, 4, v56
    s_cmp_lt_u32 s2, 216
    s_cbranch_scc1 L_noearly2
    s_mov_b32 s65, 128
    buffer_load_dwordx4 a[48:51], v56, s[56:59], s65 offen nt
    s_add_u32 s65, s65, 73728
    buffer_load_dwordx4 a[52:55], v56, s[56:59], s65 offen nt
    s_add_u32 s65, s65, 73728
    s_waitcnt vmcnt(1)
    buffer_load_dwordx4 a[56:59], v56, s[56:59], s65 offen nt
    s_add_u32 s65, s65, 73728
    s_waitcnt vmcnt(1)
    buffer_load_dwordx4 a[60:63], v56, s[56:59], s65 offen nt
    s_add_u32 s65, s65, 73728
    s_waitcnt vmcnt(1)
    buffer_load_dwordx4 a[64:67], v56, s[56:59], s65 offen nt
    s_add_u32 s65, s65, 73728
    s_waitcnt vmcnt(1)
    buffer_load_dwordx4 a[68:71], v56, s[56:59], s65 offen nt
    s_add_u32 s65, s65, 73728
    s_waitcnt vmcnt(1)
    buffer_load_dwordx4 a[72:75], v56, s[56:59], s65 offen nt
    s_add_u32 s65, s65, 73728
    s_waitcnt vmcnt(1)
    buffer_load_dwordx4 a[76:79], v56, s[56:59], s65 offen nt
    s_add_u32 s65, s65, 73728
    s_waitcnt vmcnt(1)
    buffer_load_dwordx4 a[80:83], v56, s[56:59], s65 offen nt
    s_add_u32 s65, s65, 73728
    s_waitcnt vmcnt(1)
    buffer_load_dwordx4 a[84:87], v56, s[56:59], s65 offen nt
    s_add_u32 s65, s65, 73728
    s_waitcnt vmcnt(1)
    buffer_load_dwordx4 a[88:91], v56, s[56:59], s65 offen nt
    s_add_u32 s65, s65, 73728
    s_waitcnt vmcnt(1)
    buffer_load_dwordx4 a[92:95], v56, s[56:59], s65 offen nt
L_noearly2:
    s_cmp_ge_u32 s2, 216
    s_cbranch_scc1 L_finprep
    s_sub_u32 s14, s2, 72
    s_mul_i32 s67, s14, 36864
    s_add_u32 s44, s32, s67
    s_addc_u32 s45, s33, 0
    s_mov_b32 s46, 36864
    s_mov_b32 s47, 0x20000
    s_lshl_b32 s65, s76, 3
    v_lshrrev_b32 v57, 3, v3
    v_add_u32 v57, s65, v57
    v_mul_u32_u24 v57, 1152, v57
    v_and_b32 v8, 7, v3
    v_lshl_add_u32 v57, v8, 4, v57
    s_lshr_b32 s15, s14, 1
    s_mul_i32 s15, s15, 1536
    s_and_b32 s65, s14, 1
    s_lshl_b32 s65, s65, 7
    s_add_u32 s15, s15, s65
    s_lshl_b32 s65, s76, 2
    s_add_u32 s15, s15, s65
    v_and_b32 v8, 7, v3
    v_min_u32 v8, 5, v8
    v_lshlrev_b32 v58, 8, v8
    v_lshrrev_b32 v9, 3, v3
    v_lshl_add_u32 v58, v9, 4, v58
    v_add_u32 v58, s15, v58
    v_lshlrev_b32 v59, 7, v8
    v_add_u32 v59, 1769472, v59
    v_lshrrev_b32 v84, 5, v3
    v_mul_u32_u24 v84, 2304, v84
    v_bfe_u32 v8, v3, 4, 1
    v_lshl_add_u32 v84, v8, 7, v84
    v_and_b32 v8, 7, v3
    v_lshl_add_u32 v84, v8, 4, v84
    s_mul_i32 s65, s76, 4608
    s_add_u32 s65, s65, 12288
    v_add_u32 v84, s65, v84
    s_mul_i32 s65, s76, 48
    v_add_u32 v85, s65, v3
    v_lshlrev_b32 v85, 4, v85
    s_mul_i32 s15, s14, 2304
    s_add_u32 s15, s15, 655360
    s_branch L_late
L_finprep:
    s_cmp_ge_u32 s2, 234
    s_cbranch_scc1 L_late
    s_sub_u32 s14, s2, 216
    s_mov_b32 s48, s16
    s_mov_b32 s49, s17
    s_mov_b32 s50, 1152
    s_mov_b32 s51, 0x20000
    v_and_b32 v46, 7, v3
    s_lshl_b32 s15, s14, 6
    v_lshlrev_b32 v8, 1, v46
    buffer_load_ushort v84, v8, s[48:51], s15 offen offset:0
    buffer_load_ushort v85, v8, s[48:51], s15 offen offset:16
    buffer_load_ushort v86, v8, s[48:51], s15 offen offset:32
    buffer_load_ushort v87, v8, s[48:51], s15 offen offset:48
    v_mov_b32 v8, s14
    v_lshrrev_b32 v9, 1, v8
    v_mul_u32_u24 v9, 768, v9
    v_and_b32 v2, 1, v8
    v_lshl_add_u32 v9, v2, 7, v9
    v_and_b32 v2, 7, v3
    v_lshl_add_u32 v2, v2, 4, v9
    s_mov_b64 exec, -1
    s_mov_b32 s68, 538112
    buffer_load_dwordx4 v[8:11], v2, s[52:55], s68 offen offset:0 sc1
    s_mov_b32 s68, 538112
    buffer_load_dwordx4 v[12:15], v2, s[52:55], s68 offen offset:256 sc1
    s_mov_b32 s68, 538112
    buffer_load_dwordx4 v[16:19], v2, s[52:55], s68 offen offset:512 sc1
    s_mov_b32 s68, 558848
    buffer_load_dwordx4 v[20:23], v2, s[52:55], s68 offen offset:0 sc1
    s_mov_b32 s68, 558848
    buffer_load_dwordx4 v[24:27], v2, s[52:55], s68 offen offset:256 sc1
    s_mov_b32 s68, 558848
    buffer_load_dwordx4 v[28:31], v2, s[52:55], s68 offen offset:512 sc1
    s_mov_b32 s70, 0
    s_waitcnt vmcnt(5)
    v_cmp_ne_u32_sdwa vcc, v60, v8 src0_sel:BYTE_0 src1_sel:BYTE_0
    s_cbranch_vccz Lk_70
    s_bitset1_b32 s70, 0
Lk_70:
    s_waitcnt vmcnt(4)
    v_cmp_ne_u32_sdwa vcc, v60, v12 src0_sel:BYTE_0 src1_sel:BYTE_0
    s_cbranch_vccz Lk_71
    s_bitset1_b32 s70, 1
Lk_71:
    s_waitcnt vmcnt(3)
    v_cmp_ne_u32_sdwa vcc, v60, v16 src0_sel:BYTE_0 src1_sel:BYTE_0
    s_cbranch_vccz Lk_72
    s_bitset1_b32 s70, 2
Lk_72:
    s_waitcnt vmcnt(2)
    v_cmp_ne_u32_sdwa vcc, v60, v20 src0_sel:BYTE_0 src1_sel:BYTE_0
    s_cbranch_vccz Lk_73
    s_bitset1_b32 s70, 3
Lk_73:
    s_waitcnt vmcnt(1)
    v_cmp_ne_u32_sdwa vcc, v60, v24 src0_sel:BYTE_0 src1_sel:BYTE_0
    s_cbranch_vccz Lk_74
    s_bitset1_b32 s70, 4
Lk_74:
    s_waitcnt vmcnt(0)
    v_cmp_ne_u32_sdwa vcc, v60, v28 src0_sel:BYTE_0 src1_sel:BYTE_0
    s_cbranch_vccz Lk_75
    s_bitset1_b32 s70, 5
Lk_75:
    s_cmp_eq_u32 s70, 0
    s_cbranch_scc1 Lpolled_69
    s_mov_b32 s69, 0
Lpoll_68:
    s_sleep 4
    s_bitcmp1_b32 s70, 0
    s_cbranch_scc0 Ls_76
    s_mov_b32 s68, 538112
    buffer_load_dwordx4 v[8:11], v2, s[52:55], s68 offen offset:0 sc1
Ls_76:
    s_bitcmp1_b32 s70, 1
    s_cbranch_scc0 Ls_77
    s_mov_b32 s68, 538112
    buffer_load_dwordx4 v[12:15], v2, s[52:55], s68 offen offset:256 sc1
Ls_77:
    s_bitcmp1_b32 s70, 2
    s_cbranch_scc0 Ls_78
    s_mov_b32 s68, 538112
    buffer_load_dwordx4 v[16:19], v2, s[52:55], s68 offen offset:512 sc1
Ls_78:
    s_bitcmp1_b32 s70, 3
    s_cbranch_scc0 Ls_79
    s_mov_b32 s68, 558848
    buffer_load_dwordx4 v[20:23], v2, s[52:55], s68 offen offset:0 sc1
Ls_79:
    s_bitcmp1_b32 s70, 4
    s_cbranch_scc0 Ls_80
    s_mov_b32 s68, 558848
    buffer_load_dwordx4 v[24:27], v2, s[52:55], s68 offen offset:256 sc1
Ls_80:
    s_bitcmp1_b32 s70, 5
    s_cbranch_scc0 Ls_81
    s_mov_b32 s68, 558848
    buffer_load_dwordx4 v[28:31], v2, s[52:55], s68 offen offset:512 sc1
Ls_81:
    s_waitcnt vmcnt(0)
    s_bitcmp1_b32 s70, 0
    s_cbranch_scc0 Lt_82
    v_cmp_ne_u32_sdwa vcc, v60, v8 src0_sel:BYTE_0 src1_sel:BYTE_0
    s_cbranch_vccnz Lt_82
    s_bitset0_b32 s70, 0
Lt_82:
    s_bitcmp1_b32 s70, 1
    s_cbranch_scc0 Lt_83
    v_cmp_ne_u32_sdwa vcc, v60, v12 src0_sel:BYTE_0 src1_sel:BYTE_0
    s_cbranch_vccnz Lt_83
    s_bitset0_b32 s70, 1
Lt_83:
    s_bitcmp1_b32 s70, 2
    s_cbranch_scc0 Lt_84
    v_cmp_ne_u32_sdwa vcc, v60, v16 src0_sel:BYTE_0 src1_sel:BYTE_0
    s_cbranch_vccnz Lt_84
    s_bitset0_b32 s70, 2
Lt_84:
    s_bitcmp1_b32 s70, 3
    s_cbranch_scc0 Lt_85
    v_cmp_ne_u32_sdwa vcc, v60, v20 src0_sel:BYTE_0 src1_sel:BYTE_0
    s_cbranch_vccnz Lt_85
    s_bitset0_b32 s70, 3
Lt_85:
    s_bitcmp1_b32 s70, 4
    s_cbranch_scc0 Lt_86
    v_cmp_ne_u32_sdwa vcc, v60, v24 src0_sel:BYTE_0 src1_sel:BYTE_0
    s_cbranch_vccnz Lt_86
    s_bitset0_b32 s70, 4
Lt_86:
    s_bitcmp1_b32 s70, 5
    s_cbranch_scc0 Lt_87
    v_cmp_ne_u32_sdwa vcc, v60, v28 src0_sel:BYTE_0 src1_sel:BYTE_0
    s_cbranch_vccnz Lt_87
    s_bitset0_b32 s70, 5
Lt_87:
    s_cmp_eq_u32 s70, 0
    s_cbranch_scc1 Lpolled_69
    s_add_u32 s69, s69, 1
    s_cmp_lt_u32 s69, 200000
    s_cbranch_scc1 Lpoll_68
Lpolled_69:
    v_pk_add_f32 v[8:9], v[8:9], v[12:13]
    v_pk_add_f32 v[10:11], v[10:11], v[14:15]
    v_pk_add_f32 v[8:9], v[8:9], v[16:17]
    v_pk_add_f32 v[10:11], v[10:11], v[18:19]
    v_cvt_pk_bf16_f32 v61, v8, v9
    v_lshlrev_b32 v8, 16, v61
    v_and_b32 v9, s80, v61
    v_cvt_pk_bf16_f32 v61, v10, v11
    v_lshlrev_b32 v10, 16, v61
    v_and_b32 v11, s80, v61
    v_mov_b32 v88, v8
    v_mov_b32 v89, v9
    v_mov_b32 v90, v10
    v_mov_b32 v91, v11
    v_pk_add_f32 v[20:21], v[20:21], v[24:25]
    v_pk_add_f32 v[22:23], v[22:23], v[26:27]
    v_pk_add_f32 v[20:21], v[20:21], v[28:29]
    v_pk_add_f32 v[22:23], v[22:23], v[30:31]
    v_cvt_pk_bf16_f32 v61, v20, v21
    v_lshlrev_b32 v20, 16, v61
    v_and_b32 v21, s80, v61
    v_cvt_pk_bf16_f32 v61, v22, v23
    v_lshlrev_b32 v22, 16, v61
    v_and_b32 v23, s80, v61
    v_mov_b32 v92, v20
    v_mov_b32 v93, v21
    v_mov_b32 v94, v22
    v_mov_b32 v95, v23
    v_lshlrev_b32 v84, 16, v84
    v_lshlrev_b32 v85, 16, v85
    v_lshlrev_b32 v86, 16, v86
    v_lshlrev_b32 v87, 16, v87
L_late:
    v_mov_b32 v62, 12
    s_mov_b32 s69, 0
Lspin_88:
    ds_read_b32 v61, v62
    s_waitcnt lgkmcnt(0)
    v_readfirstlane_b32 s68, v61
    s_nop 0
    s_cmp_ge_u32 s68, 4
    s_cbranch_scc1 Lspun_89
    s_sleep 2
    s_add_u32 s69, s69, 1
    s_cmp_lt_u32 s69, 800000
    s_cbranch_scc1 Lspin_88
Lspun_89:
    s_mov_b32 s65, 0
    buffer_load_dwordx4 a[0:3], v56, s[56:59], s65 offen nt
    s_add_u32 s65, s65, 73728
    buffer_load_dwordx4 a[4:7], v56, s[56:59], s65 offen nt
    s_add_u32 s65, s65, 73728
    buffer_load_dwordx4 a[8:11], v56, s[56:59], s65 offen nt
    s_add_u32 s65, s65, 73728
    buffer_load_dwordx4 a[12:15], v56, s[56:59], s65 offen nt
    s_add_u32 s65, s65, 73728
    buffer_load_dwordx4 a[16:19], v56, s[56:59], s65 offen nt
    s_add_u32 s65, s65, 73728
    buffer_load_dwordx4 a[20:23], v56, s[56:59], s65 offen nt
    s_add_u32 s65, s65, 73728
    buffer_load_dwordx4 a[24:27], v56, s[56:59], s65 offen nt
    s_add_u32 s65, s65, 73728
    buffer_load_dwordx4 a[28:31], v56, s[56:59], s65 offen nt
    s_add_u32 s65, s65, 73728
    buffer_load_dwordx4 a[32:35], v56, s[56:59], s65 offen nt
    s_add_u32 s65, s65, 73728
    buffer_load_dwordx4 a[36:39], v56, s[56:59], s65 offen nt
    s_add_u32 s65, s65, 73728
    buffer_load_dwordx4 a[40:43], v56, s[56:59], s65 offen nt
    s_add_u32 s65, s65, 73728
    buffer_load_dwordx4 a[44:47], v56, s[56:59], s65 offen nt
L_uissued:
    s_cmp_ge_u32 s2, 216
    s_cbranch_scc1 L_late2
    s_waitcnt vmcnt(0)
    buffer_load_dwordx4 a[48:51], v57, s[44:47], 0 offen offset:0 nt
    buffer_load_dwordx4 a[52:55], v57, s[44:47], 0 offen offset:128 nt
    buffer_load_dwordx4 a[56:59], v57, s[44:47], 0 offen offset:256 nt
    buffer_load_dwordx4 a[60:63], v57, s[44:47], 0 offen offset:384 nt
    buffer_load_dwordx4 a[64:67], v57, s[44:47], 0 offen offset:512 nt
    buffer_load_dwordx4 a[68:71], v57, s[44:47], 0 offen offset:640 nt
    buffer_load_dwordx4 a[72:75], v57, s[44:47], 0 offen offset:768 nt
    buffer_load_dwordx4 a[76:79], v57, s[44:47], 0 offen offset:896 nt
    buffer_load_dwordx4 a[80:83], v57, s[44:47], 0 offen offset:1024 nt
    s_setprio 3
    s_branch L_unit
L_late2:
    s_setprio 3
    s_waitcnt vmcnt(0)
L_unit:
    v_cvt_pk_bf16_f32 v8, v72, v72
    v_cvt_pk_bf16_f32 v9, v73, v73
    v_cvt_pk_bf16_f32 v10, v74, v74
    v_cvt_pk_bf16_f32 v11, v75, v75
    v_cvt_pk_bf16_f32 v12, v76, v76
    v_cvt_pk_bf16_f32 v13, v77, v77
    v_cvt_pk_bf16_f32 v14, v78, v78
    v_cvt_pk_bf16_f32 v15, v79, v79
    s_mov_b64 exec, 0xffffff
    ds_write_b128 v80, v[8:11]
    ds_write_b128 v80, v[12:15] offset:384
    s_mov_b64 exec, -1
    ds_read_b128 v[16:19], v81 offset:0
    ds_read_b128 v[20:23], v81 offset:16
    ds_read_b128 v[24:27], v81 offset:32
    ds_read_b128 v[28:31], v81 offset:384
    ds_read_b128 v[32:35], v81 offset:400
    ds_read_b128 v[36:39], v81 offset:416
    s_waitcnt lgkmcnt(0)
    v_and_b32 v8, v16, v4
    v_and_b32 v9, v16, v5
    v_and_b32 v10, v16, v6
    v_and_b32 v11, v16, v7
    v_and_b32 v12, v28, v4
    v_and_b32 v13, v28, v5
    v_and_b32 v14, v28, v6
    v_and_b32 v15, v28, v7
    v_mfma_f32_16x16x32_bf16 v[40:43], a[0:3], v[8:11], 0
    v_and_b32 v8, v17, v4
    v_and_b32 v9, v17, v5
    v_and_b32 v10, v17, v6
    v_and_b32 v11, v17, v7
    v_mfma_f32_16x16x32_bf16 v[44:47], a[0:3], v[12:15], 0
    v_and_b32 v12, v29, v4
    v_and_b32 v13, v29, v5
    v_and_b32 v14, v29, v6
    v_and_b32 v15, v29, v7
    v_mfma_f32_16x16x32_bf16 v[40:43], a[4:7], v[8:11], v[40:43]
    v_and_b32 v8, v18, v4
    v_and_b32 v9, v18, v5
    v_and_b32 v10, v18, v6
    v_and_b32 v11, v18, v7
    v_mfma_f32_16x16x32_bf16 v[44:47], a[4:7], v[12:15], v[44:47]
    v_and_b32 v12, v30, v4
    v_and_b32 v13, v30, v5
    v_and_b32 v14, v30, v6
    v_and_b32 v15, v30, v7
    v_mfma_f32_16x16x32_bf16 v[40:43], a[8:11], v[8:11], v[40:43]
    v_and_b32 v8, v19, v4
    v_and_b32 v9, v19, v5
    v_and_b32 v10, v19, v6
    v_and_b32 v11, v19, v7
    v_mfma_f32_16x16x32_bf16 v[44:47], a[8:11], v[12:15], v[44:47]
    v_and_b32 v12, v31, v4
    v_and_b32 v13, v31, v5
    v_and_b32 v14, v31, v6
    v_and_b32 v15, v31, v7
    v_mfma_f32_16x16x32_bf16 v[40:43], a[12:15], v[8:11], v[40:43]
    v_and_b32 v8, v20, v4
    v_and_b32 v9, v20, v5
    v_and_b32 v10, v20, v6
    v_and_b32 v11, v20, v7
    v_mfma_f32_16x16x32_bf16 v[44:47], a[12:15], v[12:15], v[44:47]
    v_and_b32 v12, v32, v4
    v_and_b32 v13, v32, v5
    v_and_b32 v14, v32, v6
    v_and_b32 v15, v32, v7
    v_mfma_f32_16x16x32_bf16 v[40:43], a[16:19], v[8:11], v[40:43]
    v_and_b32 v8, v21, v4
    v_and_b32 v9, v21, v5
    v_and_b32 v10, v21, v6
    v_and_b32 v11, v21, v7
    v_mfma_f32_16x16x32_bf16 v[44:47], a[16:19], v[12:15], v[44:47]
    v_and_b32 v12, v33, v4
    v_and_b32 v13, v33, v5
    v_and_b32 v14, v33, v6
    v_and_b32 v15, v33, v7
    v_mfma_f32_16x16x32_bf16 v[40:43], a[20:23], v[8:11], v[40:43]
    v_and_b32 v8, v22, v4
    v_and_b32 v9, v22, v5
    v_and_b32 v10, v22, v6
    v_and_b32 v11, v22, v7
    v_mfma_f32_16x16x32_bf16 v[44:47], a[20:23], v[12:15], v[44:47]
    v_and_b32 v12, v34, v4
    v_and_b32 v13, v34, v5
    v_and_b32 v14, v34, v6
    v_and_b32 v15, v34, v7
    v_mfma_f32_16x16x32_bf16 v[40:43], a[24:27], v[8:11], v[40:43]
    v_and_b32 v8, v23, v4
    v_and_b32 v9, v23, v5
    v_and_b32 v10, v23, v6
    v_and_b32 v11, v23, v7
    v_mfma_f32_16x16x32_bf16 v[44:47], a[24:27], v[12:15], v[44:47]
    v_and_b32 v12, v35, v4
    v_and_b32 v13, v35, v5
    v_and_b32 v14, v35, v6
    v_and_b32 v15, v35, v7
    v_mfma_f32_16x16x32_bf16 v[40:43], a[28:31], v[8:11], v[40:43]
    v_and_b32 v8, v24, v4
    v_and_b32 v9, v24, v5
    v_and_b32 v10, v24, v6
    v_and_b32 v11, v24, v7
    v_mfma_f32_16x16x32_bf16 v[44:47], a[28:31], v[12:15], v[44:47]
    v_and_b32 v12, v36, v4
    v_and_b32 v13, v36, v5
    v_and_b32 v14, v36, v6
    v_and_b32 v15, v36, v7
    v_mfma_f32_16x16x32_bf16 v[40:43], a[32:35], v[8:11], v[40:43]
    v_and_b32 v8, v25, v4
    v_and_b32 v9, v25, v5
    v_and_b32 v10, v25, v6
    v_and_b32 v11, v25, v7
    v_mfma_f32_16x16x32_bf16 v[44:47], a[32:35], v[12:15], v[44:47]
    v_and_b32 v12, v37, v4
    v_and_b32 v13, v37, v5
    v_and_b32 v14, v37, v6
    v_and_b32 v15, v37, v7
    v_mfma_f32_16x16x32_bf16 v[40:43], a[36:39], v[8:11], v[40:43]
    v_and_b32 v8, v26, v4
    v_and_b32 v9, v26, v5
    v_and_b32 v10, v26, v6
    v_and_b32 v11, v26, v7
    v_mfma_f32_16x16x32_bf16 v[44:47], a[36:39], v[12:15], v[44:47]
    v_and_b32 v12, v38, v4
    v_and_b32 v13, v38, v5
    v_and_b32 v14, v38, v6
    v_and_b32 v15, v38, v7
    v_mfma_f32_16x16x32_bf16 v[40:43], a[40:43], v[8:11], v[40:43]
    v_and_b32 v8, v27, v4
    v_and_b32 v9, v27, v5
    v_and_b32 v10, v27, v6
    v_and_b32 v11, v27, v7
    v_mfma_f32_16x16x32_bf16 v[44:47], a[40:43], v[12:15], v[44:47]
    v_and_b32 v12, v39, v4
    v_and_b32 v13, v39, v5
    v_and_b32 v14, v39, v6
    v_and_b32 v15, v39, v7
    v_mfma_f32_16x16x32_bf16 v[40:43], a[44:47], v[8:11], v[40:43]
    s_nop 0
    v_mfma_f32_16x16x32_bf16 v[44:47], a[44:47], v[12:15], v[44:47]
    s_nop 5
    v_mov_b32 v48, v40
    v_mov_b32 v49, v41
    v_mov_b32 v50, v42
    v_mov_b32 v51, v43
    v_mov_b32 v52, v44
    v_mov_b32 v53, v45
    v_mov_b32 v54, v46
    v_mov_b32 v55, v47
    v_permlane32_swap_b32 v40, v48
    v_permlane32_swap_b32 v41, v49
    v_permlane32_swap_b32 v42, v50
    v_permlane32_swap_b32 v43, v51
    v_permlane32_swap_b32 v44, v52
    v_permlane32_swap_b32 v45, v53
    v_permlane32_swap_b32 v46, v54
    v_permlane32_swap_b32 v47, v55
    v_add_f32_dpp v40, v48, v40 row_ror:8 row_mask:0xf bank_mask:0xf
    v_add_f32_dpp v41, v49, v41 row_ror:8 row_mask:0xf bank_mask:0xf
    v_add_f32_dpp v42, v50, v42 row_ror:8 row_mask:0xf bank_mask:0xf
    v_add_f32_dpp v43, v51, v43 row_ror:8 row_mask:0xf bank_mask:0xf
    v_add_f32_dpp v44, v52, v44 row_ror:8 row_mask:0xf bank_mask:0xf
    v_add_f32_dpp v45, v53, v45 row_ror:8 row_mask:0xf bank_mask:0xf
    v_add_f32_dpp v46, v54, v46 row_ror:8 row_mask:0xf bank_mask:0xf
    v_add_f32_dpp v47, v55, v47 row_ror:8 row_mask:0xf bank_mask:0xf
    v_bfi_b32 v40, s81, v60, v40
    v_bfi_b32 v41, s81, v60, v41
    v_bfi_b32 v42, s81, v60, v42
    v_bfi_b32 v43, s81, v60, v43
    v_bfi_b32 v44, s81, v60, v44
    v_bfi_b32 v45, s81, v60, v45
    v_bfi_b32 v46, s81, v60, v46
    v_bfi_b32 v47, s81, v60, v47
    s_add_u32 s65, s10, 1310720
    s_add_u32 s66, s10, 1531904
    s_mov_b64 exec, 0xff00ff
    buffer_store_dwordx4 v[40:43], v82, s[52:55], s65 offen sc1
    buffer_store_dwordx4 v[44:47], v82, s[52:55], s66 offen sc1
    s_mov_b64 exec, -1
    s_cmp_lt_u32 s2, 216
    s_cbranch_scc1 L_c1done
    v_and_b32 v8, v16, v4
    v_and_b32 v9, v16, v5
    v_and_b32 v10, v16, v6
    v_and_b32 v11, v16, v7
    v_and_b32 v12, v28, v4
    v_and_b32 v13, v28, v5
    v_and_b32 v14, v28, v6
    v_and_b32 v15, v28, v7
    v_mfma_f32_16x16x32_bf16 v[40:43], a[48:51], v[8:11], 0
    v_and_b32 v8, v17, v4
    v_and_b32 v9, v17, v5
    v_and_b32 v10, v17, v6
    v_and_b32 v11, v17, v7
    v_mfma_f32_16x16x32_bf16 v[44:47], a[48:51], v[12:15], 0
    v_and_b32 v12, v29, v4
    v_and_b32 v13, v29, v5
    v_and_b32 v14, v29, v6
    v_and_b32 v15, v29, v7
    v_mfma_f32_16x16x32_bf16 v[40:43], a[52:55], v[8:11], v[40:43]
    v_and_b32 v8, v18, v4
    v_and_b32 v9, v18, v5
    v_and_b32 v10, v18, v6
    v_and_b32 v11, v18, v7
    v_mfma_f32_16x16x32_bf16 v[44:47], a[52:55], v[12:15], v[44:47]
    v_and_b32 v12, v30, v4
    v_and_b32 v13, v30, v5
    v_and_b32 v14, v30, v6
    v_and_b32 v15, v30, v7
    v_mfma_f32_16x16x32_bf16 v[40:43], a[56:59], v[8:11], v[40:43]
    v_and_b32 v8, v19, v4
    v_and_b32 v9, v19, v5
    v_and_b32 v10, v19, v6
    v_and_b32 v11, v19, v7
    v_mfma_f32_16x16x32_bf16 v[44:47], a[56:59], v[12:15], v[44:47]
    v_and_b32 v12, v31, v4
    v_and_b32 v13, v31, v5
    v_and_b32 v14, v31, v6
    v_and_b32 v15, v31, v7
    v_mfma_f32_16x16x32_bf16 v[40:43], a[60:63], v[8:11], v[40:43]
    v_and_b32 v8, v20, v4
    v_and_b32 v9, v20, v5
    v_and_b32 v10, v20, v6
    v_and_b32 v11, v20, v7
    v_mfma_f32_16x16x32_bf16 v[44:47], a[60:63], v[12:15], v[44:47]
    v_and_b32 v12, v32, v4
    v_and_b32 v13, v32, v5
    v_and_b32 v14, v32, v6
    v_and_b32 v15, v32, v7
    v_mfma_f32_16x16x32_bf16 v[40:43], a[64:67], v[8:11], v[40:43]
    v_and_b32 v8, v21, v4
    v_and_b32 v9, v21, v5
    v_and_b32 v10, v21, v6
    v_and_b32 v11, v21, v7
    v_mfma_f32_16x16x32_bf16 v[44:47], a[64:67], v[12:15], v[44:47]
    v_and_b32 v12, v33, v4
    v_and_b32 v13, v33, v5
    v_and_b32 v14, v33, v6
    v_and_b32 v15, v33, v7
    v_mfma_f32_16x16x32_bf16 v[40:43], a[68:71], v[8:11], v[40:43]
    v_and_b32 v8, v22, v4
    v_and_b32 v9, v22, v5
    v_and_b32 v10, v22, v6
    v_and_b32 v11, v22, v7
    v_mfma_f32_16x16x32_bf16 v[44:47], a[68:71], v[12:15], v[44:47]
    v_and_b32 v12, v34, v4
    v_and_b32 v13, v34, v5
    v_and_b32 v14, v34, v6
    v_and_b32 v15, v34, v7
    v_mfma_f32_16x16x32_bf16 v[40:43], a[72:75], v[8:11], v[40:43]
    v_and_b32 v8, v23, v4
    v_and_b32 v9, v23, v5
    v_and_b32 v10, v23, v6
    v_and_b32 v11, v23, v7
    v_mfma_f32_16x16x32_bf16 v[44:47], a[72:75], v[12:15], v[44:47]
    v_and_b32 v12, v35, v4
    v_and_b32 v13, v35, v5
    v_and_b32 v14, v35, v6
    v_and_b32 v15, v35, v7
    v_mfma_f32_16x16x32_bf16 v[40:43], a[76:79], v[8:11], v[40:43]
    v_and_b32 v8, v24, v4
    v_and_b32 v9, v24, v5
    v_and_b32 v10, v24, v6
    v_and_b32 v11, v24, v7
    v_mfma_f32_16x16x32_bf16 v[44:47], a[76:79], v[12:15], v[44:47]
    v_and_b32 v12, v36, v4
    v_and_b32 v13, v36, v5
    v_and_b32 v14, v36, v6
    v_and_b32 v15, v36, v7
    v_mfma_f32_16x16x32_bf16 v[40:43], a[80:83], v[8:11], v[40:43]
    v_and_b32 v8, v25, v4
    v_and_b32 v9, v25, v5
    v_and_b32 v10, v25, v6
    v_and_b32 v11, v25, v7
    v_mfma_f32_16x16x32_bf16 v[44:47], a[80:83], v[12:15], v[44:47]
    v_and_b32 v12, v37, v4
    v_and_b32 v13, v37, v5
    v_and_b32 v14, v37, v6
    v_and_b32 v15, v37, v7
    v_mfma_f32_16x16x32_bf16 v[40:43], a[84:87], v[8:11], v[40:43]
    v_and_b32 v8, v26, v4
    v_and_b32 v9, v26, v5
    v_and_b32 v10, v26, v6
    v_and_b32 v11, v26, v7
    v_mfma_f32_16x16x32_bf16 v[44:47], a[84:87], v[12:15], v[44:47]
    v_and_b32 v12, v38, v4
    v_and_b32 v13, v38, v5
    v_and_b32 v14, v38, v6
    v_and_b32 v15, v38, v7
    v_mfma_f32_16x16x32_bf16 v[40:43], a[88:91], v[8:11], v[40:43]
    v_and_b32 v8, v27, v4
    v_and_b32 v9, v27, v5
    v_and_b32 v10, v27, v6
    v_and_b32 v11, v27, v7
    v_mfma_f32_16x16x32_bf16 v[44:47], a[88:91], v[12:15], v[44:47]
    v_and_b32 v12, v39, v4
    v_and_b32 v13, v39, v5
    v_and_b32 v14, v39, v6
    v_and_b32 v15, v39, v7
    v_mfma_f32_16x16x32_bf16 v[40:43], a[92:95], v[8:11], v[40:43]
    s_nop 0
    v_mfma_f32_16x16x32_bf16 v[44:47], a[92:95], v[12:15], v[44:47]
    s_nop 5
    v_mov_b32 v48, v40
    v_mov_b32 v49, v41
    v_mov_b32 v50, v42
    v_mov_b32 v51, v43
    v_mov_b32 v52, v44
    v_mov_b32 v53, v45
    v_mov_b32 v54, v46
    v_mov_b32 v55, v47
    v_permlane32_swap_b32 v40, v48
    v_permlane32_swap_b32 v41, v49
    v_permlane32_swap_b32 v42, v50
    v_permlane32_swap_b32 v43, v51
    v_permlane32_swap_b32 v44, v52
    v_permlane32_swap_b32 v45, v53
    v_permlane32_swap_b32 v46, v54
    v_permlane32_swap_b32 v47, v55
    v_add_f32_dpp v40, v48, v40 row_ror:8 row_mask:0xf bank_mask:0xf
    v_add_f32_dpp v41, v49, v41 row_ror:8 row_mask:0xf bank_mask:0xf
    v_add_f32_dpp v42, v50, v42 row_ror:8 row_mask:0xf bank_mask:0xf
    v_add_f32_dpp v43, v51, v43 row_ror:8 row_mask:0xf bank_mask:0xf
    v_add_f32_dpp v44, v52, v44 row_ror:8 row_mask:0xf bank_mask:0xf
    v_add_f32_dpp v45, v53, v45 row_ror:8 row_mask:0xf bank_mask:0xf
    v_add_f32_dpp v46, v54, v46 row_ror:8 row_mask:0xf bank_mask:0xf
    v_add_f32_dpp v47, v55, v47 row_ror:8 row_mask:0xf bank_mask:0xf
    v_bfi_b32 v40, s81, v60, v40
    v_bfi_b32 v41, s81, v60, v41
    v_bfi_b32 v42, s81, v60, v42
    v_bfi_b32 v43, s81, v60, v43
    v_bfi_b32 v44, s81, v60, v44
    v_bfi_b32 v45, s81, v60, v45
    v_bfi_b32 v46, s81, v60, v46
    v_bfi_b32 v47, s81, v60, v47
    s_add_u32 s65, s10, 1312256
    s_add_u32 s66, s10, 1533440
    s_mov_b64 exec, 0xff00ff
    buffer_store_dwordx4 v[40:43], v82, s[52:55], s65 offen sc1
    buffer_store_dwordx4 v[44:47], v82, s[52:55], s66 offen sc1
    s_mov_b64 exec, -1
L_c1done:
    s_mov_b64 exec, 0xffffff
    s_mov_b32 s69, 0
Lpoll_90:
    buffer_load_dwordx4 v[8:11], v83, s[52:55], 0 offen offset:0 sc1
    s_waitcnt vmcnt(0)
    v_cmp_ne_u32_sdwa vcc, v60, v8 src0_sel:BYTE_0 src1_sel:BYTE_0
    s_cbranch_vccz Lpolled_91
    s_sleep 8
    s_add_u32 s69, s69, 1
    s_cmp_lt_u32 s69, 200000
    s_cbranch_scc1 Lpoll_90
Lpolled_91:
    s_mov_b64 exec, 0xffffff
    buffer_load_dwordx4 v[8:11], v83, s[52:55], 0 offen offset:0 sc1
    buffer_load_dwordx4 v[12:15], v83, s[52:55], 0 offen offset:2304 sc1
    s_mov_b32 s68, 4608
    buffer_load_dwordx4 v[16:19], v83, s[52:55], s68 offen offset:0 sc1
    s_mov_b32 s68, 4608
    buffer_load_dwordx4 v[20:23], v83, s[52:55], s68 offen offset:2304 sc1
    s_mov_b32 s68, 9216
    buffer_load_dwordx4 v[24:27], v83, s[52:55], s68 offen offset:0 sc1
    s_mov_b32 s68, 9216
    buffer_load_dwordx4 v[28:31], v83, s[52:55], s68 offen offset:2304 sc1
    s_mov_b32 s68, 13824
    buffer_load_dwordx4 v[32:35], v83, s[52:55], s68 offen offset:0 sc1
    s_mov_b32 s68, 13824
    buffer_load_dwordx4 v[36:39], v83, s[52:55], s68 offen offset:2304 sc1
    s_mov_b32 s70, 0
    s_waitcnt vmcnt(7)
    v_cmp_ne_u32_sdwa vcc, v60, v8 src0_sel:BYTE_0 src1_sel:BYTE_0
    s_cbranch_vccz Lk_94
    s_bitset1_b32 s70, 0
Lk_94:
    s_waitcnt vmcnt(6)
    v_cmp_ne_u32_sdwa vcc, v60, v12 src0_sel:BYTE_0 src1_sel:BYTE_0
    s_cbranch_vccz Lk_95
    s_bitset1_b32 s70, 1
Lk_95:
    s_waitcnt vmcnt(5)
    v_cmp_ne_u32_sdwa vcc, v60, v16 src0_sel:BYTE_0 src1_sel:BYTE_0
    s_cbranch_vccz Lk_96
    s_bitset1_b32 s70, 2
Lk_96:
    s_waitcnt vmcnt(4)
    v_cmp_ne_u32_sdwa vcc, v60, v20 src0_sel:BYTE_0 src1_sel:BYTE_0
    s_cbranch_vccz Lk_97
    s_bitset1_b32 s70, 3
Lk_97:
    s_waitcnt vmcnt(3)
    v_cmp_ne_u32_sdwa vcc, v60, v24 src0_sel:BYTE_0 src1_sel:BYTE_0
    s_cbranch_vccz Lk_98
    s_bitset1_b32 s70, 4
Lk_98:
    s_waitcnt vmcnt(2)
    v_cmp_ne_u32_sdwa vcc, v60, v28 src0_sel:BYTE_0 src1_sel:BYTE_0
    s_cbranch_vccz Lk_99
    s_bitset1_b32 s70, 5
Lk_99:
    s_waitcnt vmcnt(1)
    v_cmp_ne_u32_sdwa vcc, v60, v32 src0_sel:BYTE_0 src1_sel:BYTE_0
    s_cbranch_vccz Lk_100
    s_bitset1_b32 s70, 6
Lk_100:
    s_waitcnt vmcnt(0)
    v_cmp_ne_u32_sdwa vcc, v60, v36 src0_sel:BYTE_0 src1_sel:BYTE_0
    s_cbranch_vccz Lk_101
    s_bitset1_b32 s70, 7
Lk_101:
    s_cmp_eq_u32 s70, 0
    s_cbranch_scc1 Lpolled_93
    s_mov_b32 s69, 0
Lpoll_92:
    s_bitcmp1_b32 s70, 0
    s_cbranch_scc0 Ls_102
    buffer_load_dwordx4 v[8:11], v83, s[52:55], 0 offen offset:0 sc1
Ls_102:
    s_bitcmp1_b32 s70, 1
    s_cbranch_scc0 Ls_103
    buffer_load_dwordx4 v[12:15], v83, s[52:55], 0 offen offset:2304 sc1
Ls_103:
    s_bitcmp1_b32 s70, 2
    s_cbranch_scc0 Ls_104
    s_mov_b32 s68, 4608
    buffer_load_dwordx4 v[16:19], v83, s[52:55], s68 offen offset:0 sc1
Ls_104:
    s_bitcmp1_b32 s70, 3
    s_cbranch_scc0 Ls_105
    s_mov_b32 s68, 4608
    buffer_load_dwordx4 v[20:23], v83, s[52:55], s68 offen offset:2304 sc1
Ls_105:
    s_bitcmp1_b32 s70, 4
    s_cbranch_scc0 Ls_106
    s_mov_b32 s68, 9216
    buffer_load_dwordx4 v[24:27], v83, s[52:55], s68 offen offset:0 sc1
Ls_106:
    s_bitcmp1_b32 s70, 5
    s_cbranch_scc0 Ls_107
    s_mov_b32 s68, 9216
    buffer_load_dwordx4 v[28:31], v83, s[52:55], s68 offen offset:2304 sc1
Ls_107:
    s_bitcmp1_b32 s70, 6
    s_cbranch_scc0 Ls_108
    s_mov_b32 s68, 13824
    buffer_load_dwordx4 v[32:35], v83, s[52:55], s68 offen offset:0 sc1
Ls_108:
    s_bitcmp1_b32 s70, 7
    s_cbranch_scc0 Ls_109
    s_mov_b32 s68, 13824
    buffer_load_dwordx4 v[36:39], v83, s[52:55], s68 offen offset:2304 sc1
Ls_109:
    s_waitcnt vmcnt(0)
    s_bitcmp1_b32 s70, 0
    s_cbranch_scc0 Lt_110
    v_cmp_ne_u32_sdwa vcc, v60, v8 src0_sel:BYTE_0 src1_sel:BYTE_0
    s_cbranch_vccnz Lt_110
    s_bitset0_b32 s70, 0
Lt_110:
    s_bitcmp1_b32 s70, 1
    s_cbranch_scc0 Lt_111
    v_cmp_ne_u32_sdwa vcc, v60, v12 src0_sel:BYTE_0 src1_sel:BYTE_0
    s_cbranch_vccnz Lt_111
    s_bitset0_b32 s70, 1
Lt_111:
    s_bitcmp1_b32 s70, 2
    s_cbranch_scc0 Lt_112
    v_cmp_ne_u32_sdwa vcc, v60, v16 src0_sel:BYTE_0 src1_sel:BYTE_0
    s_cbranch_vccnz Lt_112
    s_bitset0_b32 s70, 2
Lt_112:
    s_bitcmp1_b32 s70, 3
    s_cbranch_scc0 Lt_113
    v_cmp_ne_u32_sdwa vcc, v60, v20 src0_sel:BYTE_0 src1_sel:BYTE_0
    s_cbranch_vccnz Lt_113
    s_bitset0_b32 s70, 3
Lt_113:
    s_bitcmp1_b32 s70, 4
    s_cbranch_scc0 Lt_114
    v_cmp_ne_u32_sdwa vcc, v60, v24 src0_sel:BYTE_0 src1_sel:BYTE_0
    s_cbranch_vccnz Lt_114
    s_bitset0_b32 s70, 4
Lt_114:
    s_bitcmp1_b32 s70, 5
    s_cbranch_scc0 Lt_115
    v_cmp_ne_u32_sdwa vcc, v60, v28 src0_sel:BYTE_0 src1_sel:BYTE_0
    s_cbranch_vccnz Lt_115
    s_bitset0_b32 s70, 5
Lt_115:
    s_bitcmp1_b32 s70, 6
    s_cbranch_scc0 Lt_116
    v_cmp_ne_u32_sdwa vcc, v60, v32 src0_sel:BYTE_0 src1_sel:BYTE_0
    s_cbranch_vccnz Lt_116
    s_bitset0_b32 s70, 6
Lt_116:
    s_bitcmp1_b32 s70, 7
    s_cbranch_scc0 Lt_117
    v_cmp_ne_u32_sdwa vcc, v60, v36 src0_sel:BYTE_0 src1_sel:BYTE_0
    s_cbranch_vccnz Lt_117
    s_bitset0_b32 s70, 7
Lt_117:
    s_cmp_eq_u32 s70, 0
    s_cbranch_scc1 Lpolled_93
    s_add_u32 s69, s69, 1
    s_cmp_lt_u32 s69, 200000
    s_cbranch_scc1 Lpoll_92
Lpolled_93:
    v_pk_add_f32 v[8:9], v[8:9], v[12:13]
    v_pk_add_f32 v[10:11], v[10:11], v[14:15]
    v_pk_add_f32 v[16:17], v[16:17], v[20:21]
    v_pk_add_f32 v[18:19], v[18:19], v[22:23]
    v_pk_add_f32 v[24:25], v[24:25], v[28:29]
    v_pk_add_f32 v[26:27], v[26:27], v[30:31]
    v_pk_add_f32 v[32:33], v[32:33], v[36:37]
    v_pk_add_f32 v[34:35], v[34:35], v[38:39]
    v_pk_add_f32 v[8:9], v[8:9], v[16:17]
    v_pk_add_f32 v[10:11], v[10:11], v[18:19]
    v_pk_add_f32 v[24:25], v[24:25], v[32:33]
    v_pk_add_f32 v[26:27], v[26:27], v[34:35]
    v_pk_add_f32 v[8:9], v[8:9], v[24:25]
    v_pk_add_f32 v[10:11], v[10:11], v[26:27]
    v_pk_fma_f32 v[64:65], v[8:9], v[68:69], v[64:65]
    v_pk_fma_f32 v[66:67], v[10:11], v[70:71], v[66:67]
    v_pk_mul_f32 v[72:73], v[64:65], v[72:73]
    v_pk_mul_f32 v[74:75], v[66:67], v[74:75]
    s_mov_b64 exec, -1
    v_cvt_pk_bf16_f32 v8, v72, v72
    v_cvt_pk_bf16_f32 v9, v73, v73
    v_cvt_pk_bf16_f32 v10, v74, v74
    v_cvt_pk_bf16_f32 v11, v75, v75
    s_mov_b64 exec, 0xffffff
    ds_write_b128 v80, v[8:11]
    s_mov_b64 exec, -1
    ds_read_b128 v[16:19], v81 offset:0
    ds_read_b128 v[20:23], v81 offset:16
    ds_read_b128 v[24:27], v81 offset:32
    s_waitcnt lgkmcnt(0)
    v_and_b32 v8, v16, v4
    v_and_b32 v9, v16, v5
    v_and_b32 v10, v16, v6
    v_and_b32 v11, v16, v7
    v_and_b32 v12, v17, v4
    v_and_b32 v13, v17, v5
    v_and_b32 v14, v17, v6
    v_and_b32 v15, v17, v7
    v_mfma_f32_16x16x32_bf16 v[36:39], a[0:3], v[8:11], 0
    v_and_b32 v8, v18, v4
    v_and_b32 v9, v18, v5
    v_and_b32 v10, v18, v6
    v_and_b32 v11, v18, v7
    v_mfma_f32_16x16x32_bf16 v[36:39], a[4:7], v[12:15], v[36:39]
    v_and_b32 v12, v19, v4
    v_and_b32 v13, v19, v5
    v_and_b32 v14, v19, v6
    v_and_b32 v15, v19, v7
    v_mfma_f32_16x16x32_bf16 v[36:39], a[8:11], v[8:11], v[36:39]
    v_and_b32 v8, v20, v4
    v_and_b32 v9, v20, v5
    v_and_b32 v10, v20, v6
    v_and_b32 v11, v20, v7
    v_mfma_f32_16x16x32_bf16 v[36:39], a[12:15], v[12:15], v[36:39]
    v_and_b32 v12, v21, v4
    v_and_b32 v13, v21, v5
    v_and_b32 v14, v21, v6
    v_and_b32 v15, v21, v7
    v_mfma_f32_16x16x32_bf16 v[36:39], a[16:19], v[8:11], v[36:39]
    v_and_b32 v8, v22, v4
    v_and_b32 v9, v22, v5
    v_and_b32 v10, v22, v6
    v_and_b32 v11, v22, v7
    v_mfma_f32_16x16x32_bf16 v[36:39], a[20:23], v[12:15], v[36:39]
    v_and_b32 v12, v23, v4
    v_and_b32 v13, v23, v5
    v_and_b32 v14, v23, v6
    v_and_b32 v15, v23, v7
    v_mfma_f32_16x16x32_bf16 v[36:39], a[24:27], v[8:11], v[36:39]
    v_and_b32 v8, v24, v4
    v_and_b32 v9, v24, v5
    v_and_b32 v10, v24, v6
    v_and_b32 v11, v24, v7
    v_mfma_f32_16x16x32_bf16 v[36:39], a[28:31], v[12:15], v[36:39]
    v_and_b32 v12, v25, v4
    v_and_b32 v13, v25, v5
    v_and_b32 v14, v25, v6
    v_and_b32 v15, v25, v7
    v_mfma_f32_16x16x32_bf16 v[36:39], a[32:35], v[8:11], v[36:39]
    v_and_b32 v8, v26, v4
    v_and_b32 v9, v26, v5
    v_and_b32 v10, v26, v6
    v_and_b32 v11, v26, v7
    v_mfma_f32_16x16x32_bf16 v[36:39], a[36:39], v[12:15], v[36:39]
    v_and_b32 v12, v27, v4
    v_and_b32 v13, v27, v5
    v_and_b32 v14, v27, v6
    v_and_b32 v15, v27, v7
    v_mfma_f32_16x16x32_bf16 v[36:39], a[40:43], v[8:11], v[36:39]
    s_nop 0
    v_mfma_f32_16x16x32_bf16 v[36:39], a[44:47], v[12:15], v[36:39]
    s_nop 7
    v_mov_b32 v40, v36
    v_mov_b32 v41, v37
    v_mov_b32 v42, v38
    v_mov_b32 v43, v39
    v_permlane32_swap_b32 v36, v40
    v_permlane32_swap_b32 v37, v41
    v_permlane32_swap_b32 v38, v42
    v_permlane32_swap_b32 v39, v43
    v_add_f32_dpp v36, v40, v36 row_ror:8 row_mask:0xf bank_mask:0xf
    v_add_f32_dpp v37, v41, v37 row_ror:8 row_mask:0xf bank_mask:0xf
    v_add_f32_dpp v38, v42, v38 row_ror:8 row_mask:0xf bank_mask:0xf
    v_add_f32_dpp v39, v43, v39 row_ror:8 row_mask:0xf bank_mask:0xf
    v_bfi_b32 v36, s81, v60, v36
    v_bfi_b32 v37, s81, v60, v37
    v_bfi_b32 v38, s81, v60, v38
    v_bfi_b32 v39, s81, v60, v39
    s_add_u32 s65, s10, 1048576
    s_mov_b64 exec, 0xff00ff
    buffer_store_dwordx4 v[36:39], v82, s[52:55], s65 offen sc1
    s_mov_b64 exec, -1
    s_cmp_lt_u32 s2, 216
    s_cbranch_scc1 L_up1
    v_and_b32 v8, v16, v4
    v_and_b32 v9, v16, v5
    v_and_b32 v10, v16, v6
    v_and_b32 v11, v16, v7
    v_and_b32 v12, v17, v4
    v_and_b32 v13, v17, v5
    v_and_b32 v14, v17, v6
    v_and_b32 v15, v17, v7
    v_mfma_f32_16x16x32_bf16 v[36:39], a[48:51], v[8:11], 0
    v_and_b32 v8, v18, v4
    v_and_b32 v9, v18, v5
    v_and_b32 v10, v18, v6
    v_and_b32 v11, v18, v7
    v_mfma_f32_16x16x32_bf16 v[36:39], a[52:55], v[12:15], v[36:39]
    v_and_b32 v12, v19, v4
    v_and_b32 v13, v19, v5
    v_and_b32 v14, v19, v6
    v_and_b32 v15, v19, v7
    v_mfma_f32_16x16x32_bf16 v[36:39], a[56:59], v[8:11], v[36:39]
    v_and_b32 v8, v20, v4
    v_and_b32 v9, v20, v5
    v_and_b32 v10, v20, v6
    v_and_b32 v11, v20, v7
    v_mfma_f32_16x16x32_bf16 v[36:39], a[60:63], v[12:15], v[36:39]
    v_and_b32 v12, v21, v4
    v_and_b32 v13, v21, v5
    v_and_b32 v14, v21, v6
    v_and_b32 v15, v21, v7
    v_mfma_f32_16x16x32_bf16 v[36:39], a[64:67], v[8:11], v[36:39]
    v_and_b32 v8, v22, v4
    v_and_b32 v9, v22, v5
    v_and_b32 v10, v22, v6
    v_and_b32 v11, v22, v7
    v_mfma_f32_16x16x32_bf16 v[36:39], a[68:71], v[12:15], v[36:39]
    v_and_b32 v12, v23, v4
    v_and_b32 v13, v23, v5
    v_and_b32 v14, v23, v6
    v_and_b32 v15, v23, v7
    v_mfma_f32_16x16x32_bf16 v[36:39], a[72:75], v[8:11], v[36:39]
    v_and_b32 v8, v24, v4
    v_and_b32 v9, v24, v5
    v_and_b32 v10, v24, v6
    v_and_b32 v11, v24, v7
    v_mfma_f32_16x16x32_bf16 v[36:39], a[76:79], v[12:15], v[36:39]
    v_and_b32 v12, v25, v4
    v_and_b32 v13, v25, v5
    v_and_b32 v14, v25, v6
    v_and_b32 v15, v25, v7
    v_mfma_f32_16x16x32_bf16 v[36:39], a[80:83], v[8:11], v[36:39]
    v_and_b32 v8, v26, v4
    v_and_b32 v9, v26, v5
    v_and_b32 v10, v26, v6
    v_and_b32 v11, v26, v7
    v_mfma_f32_16x16x32_bf16 v[36:39], a[84:87], v[12:15], v[36:39]
    v_and_b32 v12, v27, v4
    v_and_b32 v13, v27, v5
    v_and_b32 v14, v27, v6
    v_and_b32 v15, v27, v7
    v_mfma_f32_16x16x32_bf16 v[36:39], a[88:91], v[8:11], v[36:39]
    s_nop 0
    v_mfma_f32_16x16x32_bf16 v[36:39], a[92:95], v[12:15], v[36:39]
    s_nop 7
    v_mov_b32 v40, v36
    v_mov_b32 v41, v37
    v_mov_b32 v42, v38
    v_mov_b32 v43, v39
    v_permlane32_swap_b32 v36, v40
    v_permlane32_swap_b32 v37, v41
    v_permlane32_swap_b32 v38, v42
    v_permlane32_swap_b32 v39, v43
    v_add_f32_dpp v36, v40, v36 row_ror:8 row_mask:0xf bank_mask:0xf
    v_add_f32_dpp v37, v41, v37 row_ror:8 row_mask:0xf bank_mask:0xf
    v_add_f32_dpp v38, v42, v38 row_ror:8 row_mask:0xf bank_mask:0xf
    v_add_f32_dpp v39, v43, v39 row_ror:8 row_mask:0xf bank_mask:0xf
    v_bfi_b32 v36, s81, v60, v36
    v_bfi_b32 v37, s81, v60, v37
    v_bfi_b32 v38, s81, v60, v38
    v_bfi_b32 v39, s81, v60, v39
    s_add_u32 s65, s10, 1050112
    s_mov_b64 exec, 0xff00ff
    buffer_store_dwordx4 v[36:39], v82, s[52:55], s65 offen sc1
    s_mov_b64 exec, -1
L_up1:
    s_or_b32 s11, s6, s8
    s_cmp_lg_u32 s11, 0
    s_cbranch_scc1 L_nostat
    v_mov_b32 v12, 0
    v_mov_b32 v13, 0
    s_mov_b64 exec, 0xffffff
    v_pk_add_f32 v[14:15], v[64:65], v[66:67]
    v_pk_mul_f32 v[16:17], v[64:65], v[64:65]
    v_pk_fma_f32 v[16:17], v[66:67], v[66:67], v[16:17]
    v_add_f32 v12, v14, v15
    v_add_f32 v13, v16, v17
    s_mov_b64 exec, -1
    v_add_f32_dpp v12, v12, v12 quad_perm:[1,0,3,2] row_mask:0xf bank_mask:0xf
    v_add_f32_dpp v13, v13, v13 quad_perm:[1,0,3,2] row_mask:0xf bank_mask:0xf
    s_nop 0
    v_add_f32_dpp v12, v12, v12 quad_perm:[2,3,0,1] row_mask:0xf bank_mask:0xf
    v_add_f32_dpp v13, v13, v13 quad_perm:[2,3,0,1] row_mask:0xf bank_mask:0xf
    s_nop 0
    v_add_f32_dpp v12, v12, v12 row_ror:4 row_mask:0xf bank_mask:0xf
    v_add_f32_dpp v13, v13, v13 row_ror:4 row_mask:0xf bank_mask:0xf
    s_nop 0
    v_add_f32_dpp v12, v12, v12 row_ror:8 row_mask:0xf bank_mask:0xf
    v_add_f32_dpp v13, v13, v13 row_ror:8 row_mask:0xf bank_mask:0xf
    v_mov_b32 v14, v12
    v_mov_b32 v15, v13
    s_nop 0
    v_permlane16_swap_b32 v12, v14
    v_permlane16_swap_b32 v13, v15
    v_add_f32 v12, v12, v14
    v_add_f32 v13, v13, v15
    v_mov_b32 v14, 0
    v_mov_b32 v15, 0
    v_bfi_b32 v12, s81, v60, v12
    v_bfi_b32 v13, s81, v60, v13
    v_bfi_b32 v14, s81, v60, v14
    v_bfi_b32 v15, s81, v60, v15
    s_lshl_b32 s11, s7, 7
    s_add_u32 s11, s11, 1769472
    s_mov_b64 exec, 1
    buffer_store_dwordx4 v[12:15], off, s[52:55], s11 sc1
    s_mov_b64 exec, -1
L_nostat:
    s_cmp_ge_u32 s2, 234
    s_cbranch_scc1 L_hexit
    s_cmp_ge_u32 s2, 216
    s_cbranch_scc1 L_fin
    v_mov_b32 v8, 0
    v_mov_b32 v9, 0
    v_mov_b32 v10, 0
    v_mov_b32 v11, 0
    v_mov_b32 v20, 0
    v_mov_b32 v21, 0
    v_mov_b32 v22, 0
    v_mov_b32 v23, 0
    s_mov_b32 exec_lo, 0x3f3f3f3f
    s_mov_b32 exec_hi, 0x3f3f3f3f
    s_mov_b32 s68, 1310720
    buffer_load_dword v20, v58, s[52:55], s68 offen offset:0 sc1
    s_mov_b32 s68, 1531904
    buffer_load_dword v21, v58, s[52:55], s68 offen offset:0 sc1
    s_mov_b32 s68, 1421312
    buffer_load_dword v22, v58, s[52:55], s68 offen offset:0 sc1
    s_mov_b32 s68, 1642496
    buffer_load_dword v23, v58, s[52:55], s68 offen offset:0 sc1
    s_mov_b32 s70, 0
    s_waitcnt vmcnt(3)
    v_cmp_ne_u32_sdwa vcc, v60, v20 src0_sel:BYTE_0 src1_sel:BYTE_0
    s_cbranch_vccz Lk_120
    s_bitset1_b32 s70, 0
Lk_120:
    s_waitcnt vmcnt(2)
    v_cmp_ne_u32_sdwa vcc, v60, v21 src0_sel:BYTE_0 src1_sel:BYTE_0
    s_cbranch_vccz Lk_121
    s_bitset1_b32 s70, 1
Lk_121:
    s_waitcnt vmcnt(1)
    v_cmp_ne_u32_sdwa vcc, v60, v22 src0_sel:BYTE_0 src1_sel:BYTE_0
    s_cbranch_vccz Lk_122
    s_bitset1_b32 s70, 2
Lk_122:
    s_waitcnt vmcnt(0)
    v_cmp_ne_u32_sdwa vcc, v60, v23 src0_sel:BYTE_0 src1_sel:BYTE_0
    s_cbranch_vccz Lk_123
    s_bitset1_b32 s70, 3
Lk_123:
    s_cmp_eq_u32 s70, 0
    s_cbranch_scc1 Lpolled_119
    s_mov_b32 s69, 0
Lpoll_118:
    s_bitcmp1_b32 s70, 0
    s_cbranch_scc0 Ls_124
    s_mov_b32 s68, 1310720
    buffer_load_dword v20, v58, s[52:55], s68 offen offset:0 sc1
Ls_124:
    s_bitcmp1_b32 s70, 1
    s_cbranch_scc0 Ls_125
    s_mov_b32 s68, 1531904
    buffer_load_dword v21, v58, s[52:55], s68 offen offset:0 sc1
Ls_125:
    s_bitcmp1_b32 s70, 2
    s_cbranch_scc0 Ls_126
    s_mov_b32 s68, 1421312
    buffer_load_dword v22, v58, s[52:55], s68 offen offset:0 sc1
Ls_126:
    s_bitcmp1_b32 s70, 3
    s_cbranch_scc0 Ls_127
    s_mov_b32 s68, 1642496
    buffer_load_dword v23, v58, s[52:55], s68 offen offset:0 sc1
Ls_127:
    s_waitcnt vmcnt(0)
    s_bitcmp1_b32 s70, 0
    s_cbranch_scc0 Lt_128
    v_cmp_ne_u32_sdwa vcc, v60, v20 src0_sel:BYTE_0 src1_sel:BYTE_0
    s_cbranch_vccnz Lt_128
    s_bitset0_b32 s70, 0
Lt_128:
    s_bitcmp1_b32 s70, 1
    s_cbranch_scc0 Lt_129
    v_cmp_ne_u32_sdwa vcc, v60, v21 src0_sel:BYTE_0 src1_sel:BYTE_0
    s_cbranch_vccnz Lt_129
    s_bitset0_b32 s70, 1
Lt_129:
    s_bitcmp1_b32 s70, 2
    s_cbranch_scc0 Lt_130
    v_cmp_ne_u32_sdwa vcc, v60, v22 src0_sel:BYTE_0 src1_sel:BYTE_0
    s_cbranch_vccnz Lt_130
    s_bitset0_b32 s70, 2
Lt_130:
    s_bitcmp1_b32 s70, 3
    s_cbranch_scc0 Lt_131
    v_cmp_ne_u32_sdwa vcc, v60, v23 src0_sel:BYTE_0 src1_sel:BYTE_0
    s_cbranch_vccnz Lt_131
    s_bitset0_b32 s70, 3
Lt_131:
    s_cmp_eq_u32 s70, 0
    s_cbranch_scc1 Lpolled_119
    s_add_u32 s69, s69, 1
    s_cmp_lt_u32 s69, 200000
    s_cbranch_scc1 Lpoll_118
Lpolled_119:
    s_mov_b64 exec, -1
    v_add_f32_dpp v20, v20, v20 quad_perm:[1,0,3,2] row_mask:0xf bank_mask:0xf
    v_add_f32_dpp v21, v21, v21 quad_perm:[1,0,3,2] row_mask:0xf bank_mask:0xf
    v_add_f32_dpp v22, v22, v22 quad_perm:[1,0,3,2] row_mask:0xf bank_mask:0xf
    v_add_f32_dpp v23, v23, v23 quad_perm:[1,0,3,2] row_mask:0xf bank_mask:0xf
    v_add_f32_dpp v20, v20, v20 quad_perm:[2,3,0,1] row_mask:0xf bank_mask:0xf
    v_add_f32_dpp v21, v21, v21 quad_perm:[2,3,0,1] row_mask:0xf bank_mask:0xf
    v_add_f32_dpp v22, v22, v22 quad_perm:[2,3,0,1] row_mask:0xf bank_mask:0xf
    v_add_f32_dpp v23, v23, v23 quad_perm:[2,3,0,1] row_mask:0xf bank_mask:0xf
    v_add_f32_dpp v20, v20, v20 row_half_mirror row_mask:0xf bank_mask:0xf
    v_add_f32_dpp v21, v21, v21 row_half_mirror row_mask:0xf bank_mask:0xf
    v_add_f32_dpp v22, v22, v22 row_half_mirror row_mask:0xf bank_mask:0xf
    v_add_f32_dpp v23, v23, v23 row_half_mirror row_mask:0xf bank_mask:0xf
    s_mov_b32 exec_lo, 0x3f3f3f3f
    s_mov_b32 exec_hi, 0x3f3f3f3f
    s_mov_b32 s68, 1048576
    buffer_load_dword v8, v58, s[52:55], s68 offen offset:0 sc1
    s_mov_b32 s68, 1159168
    buffer_load_dword v9, v58, s[52:55], s68 offen offset:0 sc1
    buffer_load_dwordx4 v[10:13], v59, s[52:55], 0 offen offset:0 sc1
    s_mov_b32 s70, 0
    s_waitcnt vmcnt(2)
    v_cmp_ne_u32_sdwa vcc, v60, v8 src0_sel:BYTE_0 src1_sel:BYTE_0
    s_cbranch_vccz Lk_134
    s_bitset1_b32 s70, 0
Lk_134:
    s_waitcnt vmcnt(1)
    v_cmp_ne_u32_sdwa vcc, v60, v9 src0_sel:BYTE_0 src1_sel:BYTE_0
    s_cbranch_vccz Lk_135
    s_bitset1_b32 s70, 1
Lk_135:
    s_waitcnt vmcnt(0)
    v_xor_b32 v61, v60, v10
    v_xor_b32 v62, v60, v11
    v_xor_b32 v63, v60, v12
    v_or3_b32 v61, v61, v62, v63
    v_xor_b32 v62, v60, v13
    v_or_b32 v61, v61, v62
    v_and_b32 v61, 0xff, v61
    v_cmp_ne_u32 vcc, 0, v61
    s_cbranch_vccz Lk_136
    s_bitset1_b32 s70, 2
Lk_136:
    s_cmp_eq_u32 s70, 0
    s_cbranch_scc1 Lpolled_133
    s_mov_b32 s69, 0
Lpoll_132:
    s_bitcmp1_b32 s70, 0
    s_cbranch_scc0 Ls_137
    s_mov_b32 s68, 1048576
    buffer_load_dword v8, v58, s[52:55], s68 offen offset:0 sc1
Ls_137:
    s_bitcmp1_b32 s70, 1
    s_cbranch_scc0 Ls_138
    s_mov_b32 s68, 1159168
    buffer_load_dword v9, v58, s[52:55], s68 offen offset:0 sc1
Ls_138:
    s_bitcmp1_b32 s70, 2
    s_cbranch_scc0 Ls_139
    buffer_load_dwordx4 v[10:13], v59, s[52:55], 0 offen offset:0 sc1
Ls_139:
    s_waitcnt vmcnt(0)
    s_bitcmp1_b32 s70, 0
    s_cbranch_scc0 Lt_140
    v_cmp_ne_u32_sdwa vcc, v60, v8 src0_sel:BYTE_0 src1_sel:BYTE_0
    s_cbranch_vccnz Lt_140
    s_bitset0_b32 s70, 0
Lt_140:
    s_bitcmp1_b32 s70, 1
    s_cbranch_scc0 Lt_141
    v_cmp_ne_u32_sdwa vcc, v60, v9 src0_sel:BYTE_0 src1_sel:BYTE_0
    s_cbranch_vccnz Lt_141
    s_bitset0_b32 s70, 1
Lt_141:
    s_bitcmp1_b32 s70, 2
    s_cbranch_scc0 Lt_142
    v_xor_b32 v61, v60, v10
    v_xor_b32 v62, v60, v11
    v_xor_b32 v63, v60, v12
    v_or3_b32 v61, v61, v62, v63
    v_xor_b32 v62, v60, v13
    v_or_b32 v61, v61, v62
    v_and_b32 v61, 0xff, v61
    v_cmp_ne_u32 vcc, 0, v61
    s_cbranch_vccnz Lt_142
    s_bitset0_b32 s70, 2
Lt_142:
    s_cmp_eq_u32 s70, 0
    s_cbranch_scc1 Lpolled_133
    s_add_u32 s69, s69, 1
    s_cmp_lt_u32 s69, 200000
    s_cbranch_scc1 Lpoll_132
Lpolled_133:
    s_mov_b64 exec, -1
    v_add_f32_dpp v8, v8, v8 quad_perm:[1,0,3,2] row_mask:0xf bank_mask:0xf
    v_add_f32_dpp v9, v9, v9 quad_perm:[1,0,3,2] row_mask:0xf bank_mask:0xf
    v_add_f32_dpp v10, v10, v10 quad_perm:[1,0,3,2] row_mask:0xf bank_mask:0xf
    v_add_f32_dpp v11, v11, v11 quad_perm:[1,0,3,2] row_mask:0xf bank_mask:0xf
    v_add_f32_dpp v8, v8, v8 quad_perm:[2,3,0,1] row_mask:0xf bank_mask:0xf
    v_add_f32_dpp v9, v9, v9 quad_perm:[2,3,0,1] row_mask:0xf bank_mask:0xf
    v_add_f32_dpp v10, v10, v10 quad_perm:[2,3,0,1] row_mask:0xf bank_mask:0xf
    v_add_f32_dpp v11, v11, v11 quad_perm:[2,3,0,1] row_mask:0xf bank_mask:0xf
    v_add_f32_dpp v8, v8, v8 row_half_mirror row_mask:0xf bank_mask:0xf
    v_add_f32_dpp v9, v9, v9 row_half_mirror row_mask:0xf bank_mask:0xf
    v_add_f32_dpp v10, v10, v10 row_half_mirror row_mask:0xf bank_mask:0xf
    v_add_f32_dpp v11, v11, v11 row_half_mirror row_mask:0xf bank_mask:0xf
    v_mul_f32 v10, 0x3ae38e39, v10
    v_mul_f32 v11, 0x3ae38e39, v11
    v_fma_f32 v11, -v10, v10, v11
    v_max_f32 v11, 0, v11
    v_add_f32 v11, 0x3727c5ac, v11
    v_rsq_f32 v11, v11
    v_fma_f32 v8, -v10, v20, v8
    v_fma_f32 v9, -v10, v22, v9
    v_fma_f32 v8, v8, v11, v21
    v_fma_f32 v9, v9, v11, v23
    v_mul_f32 v12, 0xbfb8aa3b, v8
    v_exp_f32 v12, v12
    s_nop 0
    v_add_f32 v12, 1.0, v12
    v_rcp_f32 v12, v12
    s_nop 0
    v_mul_f32 v8, v12, v9
    v_cvt_pk_bf16_f32 v8, v8, v8
    v_and_b32 v12, v8, v4
    v_and_b32 v13, v8, v5
    v_and_b32 v14, v8, v6
    v_and_b32 v15, v8, v7
    s_nop 1
    v_mfma_f32_16x16x32_bf16 v[16:19], a[48:51], v[12:15], 0
    v_mfma_f32_16x16x32_bf16 v[20:23], a[52:55], v[12:15], 0
    v_mfma_f32_16x16x32_bf16 v[24:27], a[56:59], v[12:15], 0
    v_mfma_f32_16x16x32_bf16 v[28:31], a[60:63], v[12:15], 0
    v_mfma_f32_16x16x32_bf16 v[32:35], a[64:67], v[12:15], 0
    v_mfma_f32_16x16x32_bf16 v[36:39], a[68:71], v[12:15], 0
    v_mfma_f32_16x16x32_bf16 v[40:43], a[72:75], v[12:15], 0
    v_mfma_f32_16x16x32_bf16 v[44:47], a[76:79], v[12:15], 0
    v_mfma_f32_16x16x32_bf16 v[48:51], a[80:83], v[12:15], 0
    s_mov_b32 exec_lo, 0x00ff00ff
    s_mov_b32 exec_hi, 0xff00ff00
    ds_write_b128 v84, v[16:19] offset:0
    ds_write_b128 v84, v[20:23] offset:256
    ds_write_b128 v84, v[24:27] offset:512
    ds_write_b128 v84, v[28:31] offset:768
    ds_write_b128 v84, v[32:35] offset:1024
    ds_write_b128 v84, v[36:39] offset:1280
    ds_write_b128 v84, v[40:43] offset:1536
    ds_write_b128 v84, v[44:47] offset:1792
    ds_write_b128 v84, v[48:51] offset:2048
    s_mov_b64 exec, -1
    s_waitcnt lgkmcnt(0)
    s_barrier
    s_cmp_ge_u32 s76, 3
    s_cbranch_scc1 L_hexit
    s_mov_b32 exec_lo, 0xffffffff
    s_mov_b32 exec_hi, 0x0000ffff
    ds_read_b128 v[8:11], v85 offset:12288
    ds_read_b128 v[12:15], v85 offset:14592
    ds_read_b128 v[16:19], v85 offset:16896
    ds_read_b128 v[20:23], v85 offset:19200
    ds_read_b128 v[24:27], v85 offset:21504
    ds_read_b128 v[28:31], v85 offset:23808
    ds_read_b128 v[32:35], v85 offset:26112
    ds_read_b128 v[36:39], v85 offset:28416
    s_waitcnt lgkmcnt(0)
    v_pk_add_f32 v[8:9], v[8:9], v[12:13]
    v_pk_add_f32 v[10:11], v[10:11], v[14:15]
    v_pk_add_f32 v[16:17], v[16:17], v[20:21]
    v_pk_add_f32 v[18:19], v[18:19], v[22:23]
    v_pk_add_f32 v[24:25], v[24:25], v[28:29]
    v_pk_add_f32 v[26:27], v[26:27], v[30:31]
    v_pk_add_f32 v[32:33], v[32:33], v[36:37]
    v_pk_add_f32 v[34:35], v[34:35], v[38:39]
    v_pk_add_f32 v[8:9], v[8:9], v[16:17]
    v_pk_add_f32 v[10:11], v[10:11], v[18:19]
    v_pk_add_f32 v[24:25], v[24:25], v[32:33]
    v_pk_add_f32 v[26:27], v[26:27], v[34:35]
    v_pk_add_f32 v[8:9], v[8:9], v[24:25]
    v_pk_add_f32 v[10:11], v[10:11], v[26:27]
    v_bfi_b32 v8, s81, v60, v8
    v_bfi_b32 v9, s81, v60, v9
    v_bfi_b32 v10, s81, v60, v10
    v_bfi_b32 v11, s81, v60, v11
    buffer_store_dwordx4 v[8:11], v85, s[52:55], s15 offen sc1
    s_branch L_hexit
L_fin:
    v_and_b32 v46, 7, v3
    s_lshl_b32 s15, s14, 7
    v_lshlrev_b32 v47, 4, v46
    v_add_u32 v47, s15, v47
    v_lshrrev_b32 v8, 3, v3
    v_mul_u32_u24 v42, 2304, v8
    v_add_u32 v42, v42, v47
    v_add_u32 v42, 262144, v42
    s_mul_i32 s65, s76, 36
    v_add_u32 v8, s65, v8
    v_mul_u32_u24 v43, 2304, v8
    v_add_u32 v43, v43, v47
    v_add_u32 v43, 655360, v43
    v_add_u32 v44, 73728, v43
    v_cmp_gt_u32 vcc, 32, v3
    s_nop 1
    v_cndmask_b32 v44, v43, v44, vcc
    s_lshl_b32 s65, s76, 7
    s_add_u32 s65, s65, 8192
    v_lshlrev_b32 v45, 4, v46
    v_add_u32 v40, s65, v45
    s_mov_b32 s69, 0
Lpoll_143:
    buffer_load_dwordx4 v[8:11], v42, s[52:55], 0 offen offset:0 sc1
    s_waitcnt vmcnt(0)
    v_cmp_ne_u32_sdwa vcc, v60, v8 src0_sel:BYTE_0 src1_sel:BYTE_0
    s_cbranch_vccz Lpolled_144
    s_sleep 1
    s_add_u32 s69, s69, 1
    s_cmp_lt_u32 s69, 200000
    s_cbranch_scc1 Lpoll_143
Lpolled_144:
    v_add_f32_dpp v8, v8, v8 row_ror:8 row_mask:0xf bank_mask:0xf
    v_add_f32_dpp v9, v9, v9 row_ror:8 row_mask:0xf bank_mask:0xf
    v_add_f32_dpp v10, v10, v10 row_ror:8 row_mask:0xf bank_mask:0xf
    v_add_f32_dpp v11, v11, v11 row_ror:8 row_mask:0xf bank_mask:0xf
    v_mov_b32 v12, v8
    v_mov_b32 v13, v9
    v_mov_b32 v14, v10
    v_mov_b32 v15, v11
    v_permlane16_swap_b32 v8, v12
    v_permlane16_swap_b32 v9, v13
    v_permlane16_swap_b32 v10, v14
    v_permlane16_swap_b32 v11, v15
    v_add_f32 v8, v8, v12
    v_add_f32 v9, v9, v13
    v_add_f32 v10, v10, v14
    v_add_f32 v11, v11, v15
    v_mov_b32 v12, v8
    v_mov_b32 v13, v9
    v_mov_b32 v14, v10
    v_mov_b32 v15, v11
    v_permlane32_swap_b32 v8, v12
    v_permlane32_swap_b32 v9, v13
    v_permlane32_swap_b32 v10, v14
    v_permlane32_swap_b32 v11, v15
    v_add_f32 v8, v8, v12
    v_add_f32 v9, v9, v13
    v_add_f32 v10, v10, v14
    v_add_f32 v11, v11, v15
    v_pk_fma_f32 v[84:85], v[8:9], v[88:89], v[84:85]
    v_pk_fma_f32 v[86:87], v[10:11], v[90:91], v[86:87]
    s_or_b32 s65, s14, s76
    s_cmp_lg_u32 s65, 0
    s_cbranch_scc1 L_noepoch
    s_mov_b64 exec, 1
    v_mov_b32 v8, s64
    buffer_store_dword v8, off, s[52:55], 0 sc1
    s_mov_b64 exec, -1
L_noepoch:
    s_mov_b32 s48, s38
    s_mov_b32 s49, s39
    s_mov_b32 s50, 1152
    s_mov_b32 s51, 0x20000
    s_lshl_b32 s15, s14, 6
    v_lshlrev_b32 v49, 1, v46
    v_bfe_u32 v53, v3, 3, 2
    v_mov_b32 v54, v84
    v_mov_b32 v55, v92
    v_cmp_eq_u32 vcc, 1, v53
    s_nop 1
    v_cndmask_b32 v54, v54, v85, vcc
    v_cndmask_b32 v55, v55, v93, vcc
    v_cmp_eq_u32 vcc, 2, v53
    s_nop 1
    v_cndmask_b32 v54, v54, v86, vcc
    v_cndmask_b32 v55, v55, v94, vcc
    v_cmp_eq_u32 vcc, 3, v53
    s_nop 1
    v_cndmask_b32 v54, v54, v87, vcc
    v_cndmask_b32 v55, v55, v95, vcc
    v_lshlrev_b32 v50, 4, v46
    v_lshl_add_u32 v50, v53, 2, v50
    v_lshlrev_b32 v51, 3, v53
    v_add_u32 v51, v51, v46
    v_lshlrev_b32 v51, 1, v51
    buffer_load_dwordx4 v[8:11], v43, s[52:55], 0 offen offset:0 sc1
    s_mov_b32 s68, 18432
    buffer_load_dwordx4 v[12:15], v43, s[52:55], s68 offen offset:0 sc1
    s_mov_b32 s68, 36864
    buffer_load_dwordx4 v[16:19], v43, s[52:55], s68 offen offset:0 sc1
    s_mov_b32 s68, 55296
    buffer_load_dwordx4 v[20:23], v43, s[52:55], s68 offen offset:0 sc1
    buffer_load_dwordx4 v[24:27], v44, s[52:55], 0 offen offset:0 sc1
    s_mov_b32 s70, 0
    s_waitcnt vmcnt(4)
    v_cmp_ne_u32_sdwa vcc, v60, v8 src0_sel:BYTE_0 src1_sel:BYTE_0
    s_cbranch_vccz Lk_147
    s_bitset1_b32 s70, 0
Lk_147:
    s_waitcnt vmcnt(3)
    v_cmp_ne_u32_sdwa vcc, v60, v12 src0_sel:BYTE_0 src1_sel:BYTE_0
    s_cbranch_vccz Lk_148
    s_bitset1_b32 s70, 1
Lk_148:
    s_waitcnt vmcnt(2)
    v_cmp_ne_u32_sdwa vcc, v60, v16 src0_sel:BYTE_0 src1_sel:BYTE_0
    s_cbranch_vccz Lk_149
    s_bitset1_b32 s70, 2
Lk_149:
    s_waitcnt vmcnt(1)
    v_cmp_ne_u32_sdwa vcc, v60, v20 src0_sel:BYTE_0 src1_sel:BYTE_0
    s_cbranch_vccz Lk_150
    s_bitset1_b32 s70, 3
Lk_150:
    s_waitcnt vmcnt(0)
    v_cmp_ne_u32_sdwa vcc, v60, v24 src0_sel:BYTE_0 src1_sel:BYTE_0
    s_cbranch_vccz Lk_151
    s_bitset1_b32 s70, 4
Lk_151:
    s_cmp_eq_u32 s70, 0
    s_cbranch_scc1 Lpolled_146
    s_mov_b32 s69, 0
Lpoll_145:
    s_bitcmp1_b32 s70, 0
    s_cbranch_scc0 Ls_152
    buffer_load_dwordx4 v[8:11], v43, s[52:55], 0 offen offset:0 sc1
Ls_152:
    s_bitcmp1_b32 s70, 1
    s_cbranch_scc0 Ls_153
    s_mov_b32 s68, 18432
    buffer_load_dwordx4 v[12:15], v43, s[52:55], s68 offen offset:0 sc1
Ls_153:
    s_bitcmp1_b32 s70, 2
    s_cbranch_scc0 Ls_154
    s_mov_b32 s68, 36864
    buffer_load_dwordx4 v[16:19], v43, s[52:55], s68 offen offset:0 sc1
Ls_154:
    s_bitcmp1_b32 s70, 3
    s_cbranch_scc0 Ls_155
    s_mov_b32 s68, 55296
    buffer_load_dwordx4 v[20:23], v43, s[52:55], s68 offen offset:0 sc1
Ls_155:
    s_bitcmp1_b32 s70, 4
    s_cbranch_scc0 Ls_156
    buffer_load_dwordx4 v[24:27], v44, s[52:55], 0 offen offset:0 sc1
Ls_156:
    s_waitcnt vmcnt(0)
    s_bitcmp1_b32 s70, 0
    s_cbranch_scc0 Lt_157
    v_cmp_ne_u32_sdwa vcc, v60, v8 src0_sel:BYTE_0 src1_sel:BYTE_0
    s_cbranch_vccnz Lt_157
    s_bitset0_b32 s70, 0
Lt_157:
    s_bitcmp1_b32 s70, 1
    s_cbranch_scc0 Lt_158
    v_cmp_ne_u32_sdwa vcc, v60, v12 src0_sel:BYTE_0 src1_sel:BYTE_0
    s_cbranch_vccnz Lt_158
    s_bitset0_b32 s70, 1
Lt_158:
    s_bitcmp1_b32 s70, 2
    s_cbranch_scc0 Lt_159
    v_cmp_ne_u32_sdwa vcc, v60, v16 src0_sel:BYTE_0 src1_sel:BYTE_0
    s_cbranch_vccnz Lt_159
    s_bitset0_b32 s70, 2
Lt_159:
    s_bitcmp1_b32 s70, 3
    s_cbranch_scc0 Lt_160
    v_cmp_ne_u32_sdwa vcc, v60, v20 src0_sel:BYTE_0 src1_sel:BYTE_0
    s_cbranch_vccnz Lt_160
    s_bitset0_b32 s70, 3
Lt_160:
    s_bitcmp1_b32 s70, 4
    s_cbranch_scc0 Lt_161
    v_cmp_ne_u32_sdwa vcc, v60, v24 src0_sel:BYTE_0 src1_sel:BYTE_0
    s_cbranch_vccnz Lt_161
    s_bitset0_b32 s70, 4
Lt_161:
    s_cmp_eq_u32 s70, 0
    s_cbranch_scc1 Lpolled_146
    s_add_u32 s69, s69, 1
    s_cmp_lt_u32 s69, 200000
    s_cbranch_scc1 Lpoll_145
Lpolled_146:
    v_cmp_gt_u32 vcc, 32, v3
    v_pk_add_f32 v[8:9], v[8:9], v[12:13]
    v_pk_add_f32 v[10:11], v[10:11], v[14:15]
    v_pk_add_f32 v[16:17], v[16:17], v[20:21]
    v_pk_add_f32 v[18:19], v[18:19], v[22:23]
    v_pk_add_f32 v[8:9], v[8:9], v[16:17]
    v_pk_add_f32 v[10:11], v[10:11], v[18:19]
    v_cndmask_b32 v24, 0, v24, vcc
    v_cndmask_b32 v25, 0, v25, vcc
    v_cndmask_b32 v26, 0, v26, vcc
    v_cndmask_b32 v27, 0, v27, vcc
    v_pk_add_f32 v[8:9], v[8:9], v[24:25]
    v_pk_add_f32 v[10:11], v[10:11], v[26:27]
    s_nop 0
    v_add_f32_dpp v8, v8, v8 row_ror:8 row_mask:0xf bank_mask:0xf
    v_add_f32_dpp v9, v9, v9 row_ror:8 row_mask:0xf bank_mask:0xf
    v_add_f32_dpp v10, v10, v10 row_ror:8 row_mask:0xf bank_mask:0xf
    v_add_f32_dpp v11, v11, v11 row_ror:8 row_mask:0xf bank_mask:0xf
    v_mov_b32 v12, v8
    v_mov_b32 v13, v9
    v_mov_b32 v14, v10
    v_mov_b32 v15, v11
    v_permlane16_swap_b32 v8, v12
    v_permlane16_swap_b32 v9, v13
    v_permlane16_swap_b32 v10, v14
    v_permlane16_swap_b32 v11, v15
    v_add_f32 v8, v8, v12
    v_add_f32 v9, v9, v13
    v_add_f32 v10, v10, v14
    v_add_f32 v11, v11, v15
    v_mov_b32 v12, v8
    v_mov_b32 v13, v9
    v_mov_b32 v14, v10
    v_mov_b32 v15, v11
    v_permlane32_swap_b32 v8, v12
    v_permlane32_swap_b32 v9, v13
    v_permlane32_swap_b32 v10, v14
    v_permlane32_swap_b32 v11, v15
    v_add_f32 v8, v8, v12
    v_add_f32 v9, v9, v13
    v_add_f32 v10, v10, v14
    v_add_f32 v11, v11, v15
    s_mov_b64 exec, 0xff
    ds_write_b128 v40, v[8:11]
    s_mov_b64 exec, -1
    s_waitcnt lgkmcnt(0)
    s_barrier
    s_cmp_lg_u32 s76, 0
    s_cbranch_scc1 L_hexit
    s_mov_b32 exec_lo, 0xffffffff
    s_mov_b32 exec_hi, 0x00000000
    ds_read_b32 v8, v50 offset:8192
    ds_read_b32 v9, v50 offset:8320
    ds_read_b32 v10, v50 offset:8448
    ds_read_b32 v11, v50 offset:8576
    s_waitcnt lgkmcnt(0)
    v_add_f32 v8, v8, v9
    v_add_f32 v10, v10, v11
    v_add_f32 v8, v8, v10
    v_fma_f32 v8, v8, v55, v54
    v_cvt_pk_bf16_f32 v8, v8, v8
    buffer_store_short v8, v51, s[48:51], s15 offen
    s_branch L_hexit
L_wo:
    s_and_b32 s77, s2, 7
    s_lshr_b32 s78, s2, 3
    s_lshl_b32 s67, s78, 7
    s_add_u32 s44, s24, s67
    s_addc_u32 s45, s25, 0
    s_sub_u32 s46, 4718592, s67
    s_mov_b32 s47, 0x20000
    s_lshl_b32 s79, s77, 2
    s_add_u32 s79, s79, s76
    s_lshl_b32 s65, s79, 7
    v_lshrrev_b32 v1, 3, v3
    v_add_u32 v1, s65, v1
    v_mul_u32_u24 v1, 1152, v1
    v_and_b32 v2, 7, v3
    v_lshl_add_u32 v1, v2, 4, v1
    s_branch L_wo_have
    s_mov_b32 s65, 0
    buffer_load_dwordx4 a[96:99], v1, s[44:47], s65 offen nt
    s_add_u32 s65, s65, 9216
    buffer_load_dwordx4 a[100:103], v1, s[44:47], s65 offen nt
    s_add_u32 s65, s65, 9216
    s_waitcnt vmcnt(1)
    buffer_load_dwordx4 a[104:107], v1, s[44:47], s65 offen nt
    s_add_u32 s65, s65, 9216
    s_waitcnt vmcnt(1)
    buffer_load_dwordx4 a[108:111], v1, s[44:47], s65 offen nt
    s_add_u32 s65, s65, 9216
    s_waitcnt vmcnt(1)
    buffer_load_dwordx4 a[112:115], v1, s[44:47], s65 offen nt
    s_add_u32 s65, s65, 9216
    s_waitcnt vmcnt(1)
    buffer_load_dwordx4 a[116:119], v1, s[44:47], s65 offen nt
    s_add_u32 s65, s65, 9216
    s_waitcnt vmcnt(1)
    buffer_load_dwordx4 a[120:123], v1, s[44:47], s65 offen nt
    s_add_u32 s65, s65, 9216
    s_waitcnt vmcnt(1)
    buffer_load_dwordx4 a[124:127], v1, s[44:47], s65 offen nt
    s_add_u32 s65, s65, 9216
    s_waitcnt vmcnt(1)
    buffer_load_dwordx4 a[128:131], v1, s[44:47], s65 offen nt
    s_add_u32 s65, s65, 9216
    s_waitcnt vmcnt(1)
    buffer_load_dwordx4 a[132:135], v1, s[44:47], s65 offen nt
    s_add_u32 s65, s65, 9216
    s_waitcnt vmcnt(1)
    buffer_load_dwordx4 a[136:139], v1, s[44:47], s65 offen nt
    s_add_u32 s65, s65, 9216
    s_waitcnt vmcnt(1)
    buffer_load_dwordx4 a[140:143], v1, s[44:47], s65 offen nt
    s_add_u32 s65, s65, 9216
    s_waitcnt vmcnt(1)
    buffer_load_dwordx4 a[144:147], v1, s[44:47], s65 offen nt
    s_add_u32 s65, s65, 9216
    s_waitcnt vmcnt(1)
    buffer_load_dwordx4 a[148:151], v1, s[44:47], s65 offen nt
    s_add_u32 s65, s65, 9216
    s_waitcnt vmcnt(1)
    buffer_load_dwordx4 a[152:155], v1, s[44:47], s65 offen nt
    s_add_u32 s65, s65, 9216
    s_waitcnt vmcnt(1)
    buffer_load_dwordx4 a[156:159], v1, s[44:47], s65 offen nt
L_wo_have:
    s_mul_i32 s4, s79, 5120
    s_add_u32 s4, s4, 65536
    s_mul_i32 s65, s77, 2304
    s_lshl_b32 s66, s78, 8
    s_add_u32 s65, s65, s66
    s_add_u32 s5, s65, 262144
    v_and_b32 v41, 7, v3
    v_mul_u32_u24 v41, 640, v41
    v_lshlrev_b32 v40, 3, v3
    v_and_b32 v8, 3, v3
    v_mul_u32_u24 v8, 160, v8
    v_lshrrev_b32 v42, 2, v3
    v_lshl_add_u32 v42, v42, 2, v8
    s_mul_i32 s65, s76, 768
    s_add_u32 s65, s65, 512
    v_add_u32 v42, s65, v42
    v_lshrrev_b32 v43, 3, v3
    v_mul_u32_u24 v43, 80, v43
    s_mul_i32 s65, s76, 768
    s_add_u32 s65, s65, 512
    v_add_u32 v43, s65, v43
    v_lshrrev_b32 v44, 5, v3
    v_mul_u32_u24 v44, 256, v44
    v_bfe_u32 v8, v3, 4, 1
    v_lshl_add_u32 v44, v8, 7, v44
    v_and_b32 v8, 7, v3
    v_lshl_add_u32 v44, v8, 4, v44
    s_mul_i32 s65, s76, 512
    s_add_u32 s65, s65, 4096
    v_add_u32 v44, s65, v44
    v_lshlrev_b32 v45, 4, v3
    s_add_u32 s15, s4, 3200
    s_mov_b32 s69, 0
Lpoll_162:
    buffer_load_dwordx4 v[8:11], v41, s[52:55], s4 offen offset:512 sc1
    s_waitcnt vmcnt(0)
    v_xor_b32 v61, v60, v8
    v_xor_b32 v62, v60, v9
    v_xor_b32 v63, v60, v10
    v_or3_b32 v61, v61, v62, v63
    v_xor_b32 v62, v60, v11
    v_or_b32 v61, v61, v62
    v_and_b32 v61, 0xff, v61
    v_cmp_ne_u32 vcc, 0, v61
    s_cbranch_vccz Lpolled_163
    s_sleep 32
    s_add_u32 s69, s69, 1
    s_cmp_lt_u32 s69, 200000
    s_cbranch_scc1 Lpoll_162
Lpolled_163:
    v_and_b32 v8, s80, v8
    v_mov_b32 v10, v8
    s_nop 1
    v_max_f32_dpp v10, v10, v10 quad_perm:[1,0,3,2] row_mask:0xf bank_mask:0xf
    s_nop 1
    v_max_f32_dpp v10, v10, v10 quad_perm:[2,3,0,1] row_mask:0xf bank_mask:0xf
    s_nop 1
    v_max_f32_dpp v10, v10, v10 row_half_mirror row_mask:0xf bank_mask:0xf
    v_sub_f32 v11, v8, v10
    v_mul_f32 v11, 0x3fb8aa3b, v11
    v_exp_f32 v11, v11
    s_nop 0
    v_mul_f32 v12, v11, v9
    s_nop 1
    v_add_f32_dpp v12, v12, v12 quad_perm:[1,0,3,2] row_mask:0xf bank_mask:0xf
    s_nop 1
    v_add_f32_dpp v12, v12, v12 quad_perm:[2,3,0,1] row_mask:0xf bank_mask:0xf
    s_nop 1
    v_add_f32_dpp v12, v12, v12 row_half_mirror row_mask:0xf bank_mask:0xf
    v_rcp_f32 v12, v12
    s_nop 0
    v_mul_f32 v11, v11, v12
    s_nop 1
    v_mov_b32_dpp v48, v11 row_newbcast:0 row_mask:0xf bank_mask:0xf
    v_mov_b32_dpp v49, v11 row_newbcast:1 row_mask:0xf bank_mask:0xf
    v_mov_b32_dpp v50, v11 row_newbcast:2 row_mask:0xf bank_mask:0xf
    v_mov_b32_dpp v51, v11 row_newbcast:3 row_mask:0xf bank_mask:0xf
    v_mov_b32_dpp v52, v11 row_newbcast:4 row_mask:0xf bank_mask:0xf
    v_mov_b32_dpp v53, v11 row_newbcast:5 row_mask:0xf bank_mask:0xf
    v_mov_b32_dpp v54, v11 row_newbcast:6 row_mask:0xf bank_mask:0xf
    v_mov_b32_dpp v55, v11 row_newbcast:7 row_mask:0xf bank_mask:0xf
    v_mov_b32 v62, 4
    s_mov_b32 s69, 0
Lspin_164:
    ds_read_b32 v61, v62
    s_waitcnt lgkmcnt(0)
    v_readfirstlane_b32 s68, v61
    s_nop 0
    s_cmp_ge_u32 s68, 4
    s_cbranch_scc1 Lspun_165
    s_sleep 2
    s_add_u32 s69, s69, 1
    s_cmp_lt_u32 s69, 800000
    s_cbranch_scc1 Lspin_164
Lspun_165:
    s_mov_b32 s65, 0
    buffer_load_dwordx4 a[96:99], v1, s[44:47], s65 offen nt
    s_add_u32 s65, s65, 9216
    buffer_load_dwordx4 a[100:103], v1, s[44:47], s65 offen nt
    s_add_u32 s65, s65, 9216
    buffer_load_dwordx4 a[104:107], v1, s[44:47], s65 offen nt
    s_add_u32 s65, s65, 9216
    buffer_load_dwordx4 a[108:111], v1, s[44:47], s65 offen nt
    s_add_u32 s65, s65, 9216
    buffer_load_dwordx4 a[112:115], v1, s[44:47], s65 offen nt
    s_add_u32 s65, s65, 9216
    buffer_load_dwordx4 a[116:119], v1, s[44:47], s65 offen nt
    s_add_u32 s65, s65, 9216
    buffer_load_dwordx4 a[120:123], v1, s[44:47], s65 offen nt
    s_add_u32 s65, s65, 9216
    buffer_load_dwordx4 a[124:127], v1, s[44:47], s65 offen nt
    s_add_u32 s65, s65, 9216
    buffer_load_dwordx4 a[128:131], v1, s[44:47], s65 offen nt
    s_add_u32 s65, s65, 9216
    buffer_load_dwordx4 a[132:135], v1, s[44:47], s65 offen nt
    s_add_u32 s65, s65, 9216
    buffer_load_dwordx4 a[136:139], v1, s[44:47], s65 offen nt
    s_add_u32 s65, s65, 9216
    buffer_load_dwordx4 a[140:143], v1, s[44:47], s65 offen nt
    s_add_u32 s65, s65, 9216
    buffer_load_dwordx4 a[144:147], v1, s[44:47], s65 offen nt
    s_add_u32 s65, s65, 9216
    buffer_load_dwordx4 a[148:151], v1, s[44:47], s65 offen nt
    s_add_u32 s65, s65, 9216
    buffer_load_dwordx4 a[152:155], v1, s[44:47], s65 offen nt
    s_add_u32 s65, s65, 9216
    buffer_load_dwordx4 a[156:159], v1, s[44:47], s65 offen nt
L_wissued:
    s_setprio 3
    buffer_load_dwordx2 v[8:9], v40, s[52:55], s4 offen offset:0 sc1
    buffer_load_dwordx2 v[10:11], v40, s[52:55], s4 offen offset:640 sc1
    buffer_load_dwordx2 v[12:13], v40, s[52:55], s4 offen offset:1280 sc1
    buffer_load_dwordx2 v[14:15], v40, s[52:55], s4 offen offset:1920 sc1
    buffer_load_dwordx2 v[16:17], v40, s[52:55], s4 offen offset:2560 sc1
    buffer_load_dwordx2 v[18:19], v40, s[52:55], s4 offen offset:3200 sc1
    buffer_load_dwordx2 v[20:21], v40, s[52:55], s15 offen offset:640 sc1
    buffer_load_dwordx2 v[22:23], v40, s[52:55], s15 offen offset:1280 sc1
    s_mov_b32 s70, 0
    s_waitcnt vmcnt(7)
    v_cmp_ne_u32_sdwa vcc, v60, v8 src0_sel:BYTE_0 src1_sel:BYTE_0
    s_cbranch_vccz Lk_168
    s_bitset1_b32 s70, 0
Lk_168:
    s_waitcnt vmcnt(6)
    v_cmp_ne_u32_sdwa vcc, v60, v10 src0_sel:BYTE_0 src1_sel:BYTE_0
    s_cbranch_vccz Lk_169
    s_bitset1_b32 s70, 1
Lk_169:
    s_waitcnt vmcnt(5)
    v_cmp_ne_u32_sdwa vcc, v60, v12 src0_sel:BYTE_0 src1_sel:BYTE_0
    s_cbranch_vccz Lk_170
    s_bitset1_b32 s70, 2
Lk_170:
    s_waitcnt vmcnt(4)
    v_cmp_ne_u32_sdwa vcc, v60, v14 src0_sel:BYTE_0 src1_sel:BYTE_0
    s_cbranch_vccz Lk_171
    s_bitset1_b32 s70, 3
Lk_171:
    s_waitcnt vmcnt(3)
    v_cmp_ne_u32_sdwa vcc, v60, v16 src0_sel:BYTE_0 src1_sel:BYTE_0
    s_cbranch_vccz Lk_172
    s_bitset1_b32 s70, 4
Lk_172:
    s_waitcnt vmcnt(2)
    v_cmp_ne_u32_sdwa vcc, v60, v18 src0_sel:BYTE_0 src1_sel:BYTE_0
    s_cbranch_vccz Lk_173
    s_bitset1_b32 s70, 5
Lk_173:
    s_waitcnt vmcnt(1)
    v_cmp_ne_u32_sdwa vcc, v60, v20 src0_sel:BYTE_0 src1_sel:BYTE_0
    s_cbranch_vccz Lk_174
    s_bitset1_b32 s70, 6
Lk_174:
    s_waitcnt vmcnt(0)
    v_cmp_ne_u32_sdwa vcc, v60, v22 src0_sel:BYTE_0 src1_sel:BYTE_0
    s_cbranch_vccz Lk_175
    s_bitset1_b32 s70, 7
Lk_175:
    s_cmp_eq_u32 s70, 0
    s_cbranch_scc1 Lpolled_167
    s_mov_b32 s69, 0
Lpoll_166:
    s_bitcmp1_b32 s70, 0
    s_cbranch_scc0 Ls_176
    buffer_load_dwordx2 v[8:9], v40, s[52:55], s4 offen offset:0 sc1
Ls_176:
    s_bitcmp1_b32 s70, 1
    s_cbranch_scc0 Ls_177
    buffer_load_dwordx2 v[10:11], v40, s[52:55], s4 offen offset:640 sc1
Ls_177:
    s_bitcmp1_b32 s70, 2
    s_cbranch_scc0 Ls_178
    buffer_load_dwordx2 v[12:13], v40, s[52:55], s4 offen offset:1280 sc1
Ls_178:
    s_bitcmp1_b32 s70, 3
    s_cbranch_scc0 Ls_179
    buffer_load_dwordx2 v[14:15], v40, s[52:55], s4 offen offset:1920 sc1
Ls_179:
    s_bitcmp1_b32 s70, 4
    s_cbranch_scc0 Ls_180
    buffer_load_dwordx2 v[16:17], v40, s[52:55], s4 offen offset:2560 sc1
Ls_180:
    s_bitcmp1_b32 s70, 5
    s_cbranch_scc0 Ls_181
    buffer_load_dwordx2 v[18:19], v40, s[52:55], s4 offen offset:3200 sc1
Ls_181:
    s_bitcmp1_b32 s70, 6
    s_cbranch_scc0 Ls_182
    buffer_load_dwordx2 v[20:21], v40, s[52:55], s15 offen offset:640 sc1
Ls_182:
    s_bitcmp1_b32 s70, 7
    s_cbranch_scc0 Ls_183
    buffer_load_dwordx2 v[22:23], v40, s[52:55], s15 offen offset:1280 sc1
Ls_183:
    s_waitcnt vmcnt(0)
    s_bitcmp1_b32 s70, 0
    s_cbranch_scc0 Lt_184
    v_cmp_ne_u32_sdwa vcc, v60, v8 src0_sel:BYTE_0 src1_sel:BYTE_0
    s_cbranch_vccnz Lt_184
    s_bitset0_b32 s70, 0
Lt_184:
    s_bitcmp1_b32 s70, 1
    s_cbranch_scc0 Lt_185
    v_cmp_ne_u32_sdwa vcc, v60, v10 src0_sel:BYTE_0 src1_sel:BYTE_0
    s_cbranch_vccnz Lt_185
    s_bitset0_b32 s70, 1
Lt_185:
    s_bitcmp1_b32 s70, 2
    s_cbranch_scc0 Lt_186
    v_cmp_ne_u32_sdwa vcc, v60, v12 src0_sel:BYTE_0 src1_sel:BYTE_0
    s_cbranch_vccnz Lt_186
    s_bitset0_b32 s70, 2
Lt_186:
    s_bitcmp1_b32 s70, 3
    s_cbranch_scc0 Lt_187
    v_cmp_ne_u32_sdwa vcc, v60, v14 src0_sel:BYTE_0 src1_sel:BYTE_0
    s_cbranch_vccnz Lt_187
    s_bitset0_b32 s70, 3
Lt_187:
    s_bitcmp1_b32 s70, 4
    s_cbranch_scc0 Lt_188
    v_cmp_ne_u32_sdwa vcc, v60, v16 src0_sel:BYTE_0 src1_sel:BYTE_0
    s_cbranch_vccnz Lt_188
    s_bitset0_b32 s70, 4
Lt_188:
    s_bitcmp1_b32 s70, 5
    s_cbranch_scc0 Lt_189
    v_cmp_ne_u32_sdwa vcc, v60, v18 src0_sel:BYTE_0 src1_sel:BYTE_0
    s_cbranch_vccnz Lt_189
    s_bitset0_b32 s70, 5
Lt_189:
    s_bitcmp1_b32 s70, 6
    s_cbranch_scc0 Lt_190
    v_cmp_ne_u32_sdwa vcc, v60, v20 src0_sel:BYTE_0 src1_sel:BYTE_0
    s_cbranch_vccnz Lt_190
    s_bitset0_b32 s70, 6
Lt_190:
    s_bitcmp1_b32 s70, 7
    s_cbranch_scc0 Lt_191
    v_cmp_ne_u32_sdwa vcc, v60, v22 src0_sel:BYTE_0 src1_sel:BYTE_0
    s_cbranch_vccnz Lt_191
    s_bitset0_b32 s70, 7
Lt_191:
    s_cmp_eq_u32 s70, 0
    s_cbranch_scc1 Lpolled_167
    s_add_u32 s69, s69, 1
    s_cmp_lt_u32 s69, 200000
    s_cbranch_scc1 Lpoll_166
Lpolled_167:
    v_pk_mul_f32 v[24:25], v[8:9], v[48:49] op_sel_hi:[1,0]
    v_pk_mul_f32 v[26:27], v[10:11], v[48:49] op_sel:[0,1]
    v_pk_fma_f32 v[24:25], v[12:13], v[50:51], v[24:25] op_sel_hi:[1,0,1]
    v_pk_fma_f32 v[26:27], v[14:15], v[50:51], v[26:27] op_sel:[0,1,0]
    v_pk_fma_f32 v[24:25], v[16:17], v[52:53], v[24:25] op_sel_hi:[1,0,1]
    v_pk_fma_f32 v[26:27], v[18:19], v[52:53], v[26:27] op_sel:[0,1,0]
    v_pk_fma_f32 v[24:25], v[20:21], v[54:55], v[24:25] op_sel_hi:[1,0,1]
    v_pk_fma_f32 v[26:27], v[22:23], v[54:55], v[26:27] op_sel:[0,1,0]
    s_nop 0
    v_pk_add_f32 v[24:25], v[24:25], v[26:27]
    v_cvt_pk_bf16_f32 v24, v24, v24
    v_cvt_pk_bf16_f32 v25, v25, v25
    ds_write_b32 v42, v24
    ds_write_b32 v42, v25 offset:80
    ds_read_b128 v[16:19], v43 offset:0
    ds_read_b128 v[20:23], v43 offset:16
    ds_read_b128 v[24:27], v43 offset:32
    ds_read_b128 v[28:31], v43 offset:48
    s_waitcnt lgkmcnt(0)
    v_and_b32 v8, v16, v4
    v_and_b32 v9, v16, v5
    v_and_b32 v10, v16, v6
    v_and_b32 v11, v16, v7
    v_and_b32 v12, v17, v4
    v_and_b32 v13, v17, v5
    v_and_b32 v14, v17, v6
    v_and_b32 v15, v17, v7
    v_mfma_f32_16x16x32_bf16 v[36:39], a[96:99], v[8:11], 0
    v_and_b32 v8, v18, v4
    v_and_b32 v9, v18, v5
    v_and_b32 v10, v18, v6
    v_and_b32 v11, v18, v7
    v_mfma_f32_16x16x32_bf16 v[36:39], a[100:103], v[12:15], v[36:39]
    v_and_b32 v12, v19, v4
    v_and_b32 v13, v19, v5
    v_and_b32 v14, v19, v6
    v_and_b32 v15, v19, v7
    v_mfma_f32_16x16x32_bf16 v[36:39], a[104:107], v[8:11], v[36:39]
    v_and_b32 v8, v20, v4
    v_and_b32 v9, v20, v5
    v_and_b32 v10, v20, v6
    v_and_b32 v11, v20, v7
    v_mfma_f32_16x16x32_bf16 v[36:39], a[108:111], v[12:15], v[36:39]
    v_and_b32 v12, v21, v4
    v_and_b32 v13, v21, v5
    v_and_b32 v14, v21, v6
    v_and_b32 v15, v21, v7
    v_mfma_f32_16x16x32_bf16 v[36:39], a[112:115], v[8:11], v[36:39]
    v_and_b32 v8, v22, v4
    v_and_b32 v9, v22, v5
    v_and_b32 v10, v22, v6
    v_and_b32 v11, v22, v7
    v_mfma_f32_16x16x32_bf16 v[36:39], a[116:119], v[12:15], v[36:39]
    v_and_b32 v12, v23, v4
    v_and_b32 v13, v23, v5
    v_and_b32 v14, v23, v6
    v_and_b32 v15, v23, v7
    v_mfma_f32_16x16x32_bf16 v[36:39], a[120:123], v[8:11], v[36:39]
    v_and_b32 v8, v24, v4
    v_and_b32 v9, v24, v5
    v_and_b32 v10, v24, v6
    v_and_b32 v11, v24, v7
    v_mfma_f32_16x16x32_bf16 v[36:39], a[124:127], v[12:15], v[36:39]
    v_and_b32 v12, v25, v4
    v_and_b32 v13, v25, v5
    v_and_b32 v14, v25, v6
    v_and_b32 v15, v25, v7
    v_mfma_f32_16x16x32_bf16 v[36:39], a[128:131], v[8:11], v[36:39]
    v_and_b32 v8, v26, v4
    v_and_b32 v9, v26, v5
    v_and_b32 v10, v26, v6
    v_and_b32 v11, v26, v7
    v_mfma_f32_16x16x32_bf16 v[36:39], a[132:135], v[12:15], v[36:39]
    v_and_b32 v12, v27, v4
    v_and_b32 v13, v27, v5
    v_and_b32 v14, v27, v6
    v_and_b32 v15, v27, v7
    v_mfma_f32_16x16x32_bf16 v[36:39], a[136:139], v[8:11], v[36:39]
    v_and_b32 v8, v28, v4
    v_and_b32 v9, v28, v5
    v_and_b32 v10, v28, v6
    v_and_b32 v11, v28, v7
    v_mfma_f32_16x16x32_bf16 v[36:39], a[140:143], v[12:15], v[36:39]
    v_and_b32 v12, v29, v4
    v_and_b32 v13, v29, v5
    v_and_b32 v14, v29, v6
    v_and_b32 v15, v29, v7
    v_mfma_f32_16x16x32_bf16 v[36:39], a[144:147], v[8:11], v[36:39]
    v_and_b32 v8, v30, v4
    v_and_b32 v9, v30, v5
    v_and_b32 v10, v30, v6
    v_and_b32 v11, v30, v7
    v_mfma_f32_16x16x32_bf16 v[36:39], a[148:151], v[12:15], v[36:39]
    v_and_b32 v12, v31, v4
    v_and_b32 v13, v31, v5
    v_and_b32 v14, v31, v6
    v_and_b32 v15, v31, v7
    v_mfma_f32_16x16x32_bf16 v[36:39], a[152:155], v[8:11], v[36:39]
    s_nop 0
    v_mfma_f32_16x16x32_bf16 v[36:39], a[156:159], v[12:15], v[36:39]
    s_mov_b32 exec_lo, 0x00ff00ff
    s_mov_b32 exec_hi, 0xff00ff00
    s_nop 5
    ds_write_b128 v44, v[36:39]
    s_mov_b64 exec, -1
    s_waitcnt lgkmcnt(0)
    s_barrier
    s_cmp_lg_u32 s76, 0
    s_cbranch_scc1 L_hexit
    s_mov_b64 exec, 0xffff
    ds_read_b128 v[8:11], v45 offset:4096
    ds_read_b128 v[12:15], v45 offset:4352
    ds_read_b128 v[16:19], v45 offset:4608
    ds_read_b128 v[20:23], v45 offset:4864
    ds_read_b128 v[24:27], v45 offset:5120
    ds_read_b128 v[28:31], v45 offset:5376
    ds_read_b128 v[32:35], v45 offset:5632
    ds_read_b128 v[36:39], v45 offset:5888
    s_waitcnt lgkmcnt(0)
    v_pk_add_f32 v[8:9], v[8:9], v[12:13]
    v_pk_add_f32 v[10:11], v[10:11], v[14:15]
    v_pk_add_f32 v[16:17], v[16:17], v[20:21]
    v_pk_add_f32 v[18:19], v[18:19], v[22:23]
    v_pk_add_f32 v[24:25], v[24:25], v[28:29]
    v_pk_add_f32 v[26:27], v[26:27], v[30:31]
    v_pk_add_f32 v[32:33], v[32:33], v[36:37]
    v_pk_add_f32 v[34:35], v[34:35], v[38:39]
    v_pk_add_f32 v[8:9], v[8:9], v[16:17]
    v_pk_add_f32 v[10:11], v[10:11], v[18:19]
    v_pk_add_f32 v[24:25], v[24:25], v[32:33]
    v_pk_add_f32 v[26:27], v[26:27], v[34:35]
    v_pk_add_f32 v[8:9], v[8:9], v[24:25]
    v_pk_add_f32 v[10:11], v[10:11], v[26:27]
    v_bfi_b32 v8, s81, v60, v8
    v_bfi_b32 v9, s81, v60, v9
    v_bfi_b32 v10, s81, v60, v10
    v_bfi_b32 v11, s81, v60, v11
    buffer_store_dwordx4 v[8:11], v45, s[52:55], s5 offen sc1
L_hexit:
    s_endpgm
L_exit:
    s_endpgm
.section .rodata,"a"
.p2align 6
.amdhsa_kernel adaLN_cond__mha_block_cached__glu_gated_glu__decode_kernel
  .amdhsa_next_free_vgpr 256
  .amdhsa_next_free_sgpr 102
  .amdhsa_accum_offset 96
  .amdhsa_group_segment_fixed_size 0
  .amdhsa_kernarg_size 112
  .amdhsa_user_sgpr_count 2
  .amdhsa_user_sgpr_kernarg_segment_ptr 1
  .amdhsa_system_sgpr_workgroup_id_x 1
.end_amdhsa_kernel
```
